```python
import torch

def _softmax(x, axis=-1):
    return torch.softmax(x, dim=axis)
def _gelu(x):
    return torch.nn.functional.gelu(x, approximate="tanh")
def _silu(x):
    return torch.nn.functional.silu(x)
def _sigmoid(x):
    return torch.sigmoid(x)
def _layernorm(x, axis=-1, eps=1e-5):
    m = x.mean(dim=axis, keepdim=True)
    v = x.var(dim=axis, keepdim=True, unbiased=False)
    return (x - m) / torch.sqrt(v + eps)
def _scatter_add(tgt, idx, src, axis=0):
    return tgt.clone().index_add_(axis, idx, src)
def _segment_sum(src, seg, n):
    out = torch.zeros((n,) + src.shape[1:], dtype=src.dtype)
    return out.index_add_(0, seg, src)
def _pad(x, pw):
    flat = tuple(v for pair in reversed(pw) for v in pair)
    return torch.nn.functional.pad(x, flat)

kernel_name = 'standalone__gqa_block_cached__near_ridge'

def setup_inputs():

    _w = (lambda a: (lambda t: t.to(torch.bfloat16) if t.is_floating_point() else t)(torch.as_tensor(a)))
    B, Sq, D = 8, 96, 448
    Hq, Hkv, Sk, Dh = 16, 8, 1024, 256
    assert Hq % Hkv == 0, (Hq, Hkv)
    return {
        "x": _w((lambda *s: torch.randn(*s, dtype=torch.bfloat16) * 0.8)(B, Sq, D)),
        "k_cache": _w((lambda *s: torch.randn(*s, dtype=torch.bfloat16) * 0.8)(B, Hkv, Sk, Dh)),
        "v_cache": _w((lambda *s: torch.randn(*s, dtype=torch.bfloat16) * 0.05)(B, Hkv, Sk, Dh)),
        "wq": _w((lambda *s: torch.randn(*s, dtype=torch.bfloat16) * 0.8)(D, Hq * Dh) * (D ** -0.5)),
        "wo": _w((lambda *s: torch.randn(*s, dtype=torch.bfloat16) * 0.05)(Hq * Dh, D) * ((Hq * Dh) ** -0.5)),
    }

def reference(x, k_cache, v_cache, wq, wo):
    B, Sq, D = x.shape
    Hq, Dh = 16, 256
    Hkv = k_cache.shape[1]
    rep = Hq // Hkv
    q = (lambda x, *d: x.permute(*d))((x @ wq).reshape(B, Sq, Hq, Dh), 0, 2, 1, 3)
    k = (lambda x, n, axis: torch.repeat_interleave(x, n, dim=axis))(k_cache, rep, axis=1)
    v = (lambda x, n, axis: torch.repeat_interleave(x, n, dim=axis))(v_cache, rep, axis=1)
    scores = torch.einsum("bhqd,bhkd->bhqk", q, k) * (Dh ** -0.5)
    p = _softmax(scores, axis=-1)
    o = torch.einsum("bhqk,bhkd->bhqd", p, v)
    return (lambda x, *d: x.permute(*d))(o, 0, 2, 1, 3).reshape(B, Sq, Hq * Dh) @ wo
```

```asm
; @launch grid=(256,1,1) block=(256,1,1) lds=163840
.amdgcn_target "amdgcn-amd-amdhsa--gfx950"
.text
.p2align 12
.globl standalone__gqa_block_cached__near_ridge_kernel
.p2align 8
.type standalone__gqa_block_cached__near_ridge_kernel,@function
standalone__gqa_block_cached__near_ridge_kernel:
  s_cmp_ge_u32 s2, 256
  s_cbranch_scc1 L_end
  s_load_dwordx16 s[40:55], s[0:1], 0
  s_lshr_b32 s81, s2, 3
  s_getpc_b64 s[4:5]
  s_mul_i32 s82, s81, 1024
  v_lshl_add_u32 v250, v0, 7, s82
  v_mov_b32 v251, 0
  v_cmp_gt_u32 vcc, 8, v0
  v_lshl_add_u64 v[252:253], v[250:251], 0, s[4:5]
  s_and_saveexec_b64 s[6:7], vcc
  s_cbranch_execz L_nopf
  global_load_dword v255, v[252:253], off
L_nopf:
  s_mov_b64 exec, -1
  v_lshrrev_b32 v43, 6, v0
  v_and_b32 v1, 63, v0
  v_readfirstlane_b32 s56, v43
  s_and_b32 s57, s2, 7
  s_and_b32 s59, s81, 1
  s_bfe_u32 s60, s81, 0x10001
  s_lshr_b32 s58, s81, 2
  s_lshl1_add_u32 s61, s57, s59
  v_lshrrev_b32 v43, 3, v1
  v_and_b32 v44, 7, v1
  v_lshrrev_b32 v45, 4, v1
  s_and_b32 s82, s81, 3
  s_lshl1_add_u32 s82, s82, s58
  s_cmp_ge_u32 s82, 7
  s_cselect_b32 s95, 7, 0
  s_sub_u32 s5, s82, s95
  s_mul_i32 s4, s58, 86016
  s_lshl2_add_u32 s3, s61, s56
  s_lshl_b32 s3, s3, 7
  s_lshl_b32 s95, s60, 18
  s_add_u32 s3, s3, s95
  s_lshl_b32 s67, s5, 7
  s_add_u32 s67, s67, s4
  s_lshl_b32 s74, s5, 19
  s_add_u32 s74, s74, s3
  s_lshl_b32 s64, s56, 13
  s_lshl1_add_u32 s65, s64, 65536
  s_mul_i32 s66, s56, 3072
  s_lshl1_add_u32 s81, s60, s56
  s_and_b32 s81, s81, 3
  s_mul_i32 s81, s81, 21504
  s_and_b32 s82, s56, 1
  s_lshl_b32 s82, s82, 6
  v_xor_b32 v46, v45, v44
  v_lshlrev_b32 v46, 4, v46
  v_xor_b32 v46, s82, v46
  v_mul_u32_u24 v47, 896, v43
  v_add3_u32 v18, v46, v47, s81
  v_xor_b32 v46, 64, v46
  v_add3_u32 v19, v46, v47, s81
  v_add_u32 v19, 6144, v19
  v_add_u32 v20, 12288, v18
  v_lshlrev_b32 v46, 1, v45
  v_xor_b32 v46, v46, v44
  v_lshlrev_b32 v46, 4, v46
  v_and_b32 v47, 4, v43
  v_add_u32 v47, v47, v43
  v_lshl_add_u32 v14, v47, 13, v46
  v_add_u32 v15, 130048, v14
  v_add_u32 v16, 30720, v14
  v_add_u32 v17, 160768, v14
  s_mov_b32 s10, 688128
  s_mov_b32 s11, 0x20000
  s_mov_b32 s22, 3670016
  s_mov_b32 s23, 0x20000
  s_and_b32 s95, s2, 31
  s_cselect_b32 s34, 0, 18432
  s_mov_b32 s35, 0x20000
  s_mul_i32 s95, s58, 32768
  v_mul_u32_u24 v44, 128, v0
  v_mov_b32 v39, 0
  s_waitcnt lgkmcnt(0)
  s_add_u32 s32, s54, s95
  s_addc_u32 s33, s55, 0
  buffer_store_dword v39, v44, s[32:35], 0 offen sc1
  s_mov_b64 s[8:9], s[40:41]
  s_mov_b64 s[20:21], s[46:47]
  s_add_u32 m0, s66, 0
  s_nop 0
  buffer_load_dwordx4 v18, s[8:11], s67 offen lds
  buffer_load_dwordx4 v19, s[8:11], s67 offen offset:1024 lds
  buffer_load_dwordx4 v20, s[8:11], s67 offen offset:2048 lds
  s_add_u32 m0, s65, 0
  s_nop 0
  buffer_load_dwordx4 v14, s[20:23], s74 offen lds
  buffer_load_dwordx4 v15, s[20:23], s74 offen offset:1024 lds
  buffer_load_dwordx4 v16, s[20:23], s74 offen offset:2048 lds
  buffer_load_dwordx4 v17, s[20:23], s74 offen offset:3072 lds
  s_add_u32 s5, s5, 1
  s_cmp_ge_u32 s5, 7
  s_cselect_b32 s5, 0, s5
  s_lshl_b32 s68, s5, 7
  s_add_u32 s68, s68, s4
  s_lshl_b32 s75, s5, 19
  s_add_u32 s75, s75, s3
  s_add_u32 s5, s5, 1
  s_cmp_ge_u32 s5, 7
  s_cselect_b32 s5, 0, s5
  s_lshl_b32 s69, s5, 7
  s_add_u32 s69, s69, s4
  s_lshl_b32 s76, s5, 19
  s_add_u32 s76, s76, s3
  s_add_u32 s5, s5, 1
  s_cmp_ge_u32 s5, 7
  s_cselect_b32 s5, 0, s5
  s_lshl_b32 s70, s5, 7
  s_add_u32 s70, s70, s4
  s_lshl_b32 s77, s5, 19
  s_add_u32 s77, s77, s3
  s_add_u32 s5, s5, 1
  s_cmp_ge_u32 s5, 7
  s_cselect_b32 s5, 0, s5
  s_lshl_b32 s71, s5, 7
  s_add_u32 s71, s71, s4
  s_lshl_b32 s78, s5, 19
  s_add_u32 s78, s78, s3
  s_add_u32 s5, s5, 1
  s_cmp_ge_u32 s5, 7
  s_cselect_b32 s5, 0, s5
  s_lshl_b32 s72, s5, 7
  s_add_u32 s72, s72, s4
  s_lshl_b32 s79, s5, 19
  s_add_u32 s79, s79, s3
  s_add_u32 s5, s5, 1
  s_cmp_ge_u32 s5, 7
  s_cselect_b32 s5, 0, s5
  s_lshl_b32 s73, s5, 7
  s_add_u32 s73, s73, s4
  s_lshl_b32 s80, s5, 19
  s_add_u32 s80, s80, s3
  v_and_b32 v60, 15, v1
  v_lshrrev_b32 v61, 1, v60
  v_xor_b32 v61, v61, v45
  v_lshlrev_b32 v61, 4, v61
  v_lshl_add_u32 v61, v60, 7, v61
  s_lshl_b32 s81, s60, 6
  v_xor_b32 v29, s81, v61
  v_xor_b32 v30, 64, v29
  v_lshrrev_b32 v61, 2, v1
  v_lshlrev_b32 v61, 7, v61
  v_bfe_u32 v62, v1, 3, 2
  v_lshl_add_u32 v61, v62, 5, v61
  v_and_b32 v62, 3, v1
  v_lshl_add_u32 v61, v62, 3, v61
  v_add_u32 v25, s65, v61
  v_xor_b32 v26, 32, v25
  v_xor_b32 v27, 64, v25
  v_xor_b32 v28, 96, v25
  s_mov_b64 s[12:13], s[42:43]
  s_mov_b32 s14, 33554432
  s_mov_b32 s15, 0x20000
  s_mov_b64 s[16:17], s[44:45]
  s_mov_b32 s18, 33554432
  s_mov_b32 s19, 0x20000
  s_mov_b64 s[32:33], s[54:55]
  s_mov_b32 s34, 67108864
  s_mov_b32 s35, 0x20000
  s_mov_b64 s[36:37], s[52:53]
  s_mov_b32 s38, 256
  s_mov_b32 s39, 0x20000
  s_mov_b64 s[24:25], s[48:49]
  s_mov_b32 s26, 3670016
  s_mov_b32 s27, 0x20000
  s_mov_b64 s[28:29], s[50:51]
  s_mov_b32 s30, 688128
  s_mov_b32 s31, 0x20000
  v_lshl_add_u32 v10, v43, 9, v46
  v_add_u32 v11, 3072, v10
  v_add_u32 v12, 14336, v10
  v_add_u32 v13, 17408, v10
  v_mul_u32_u24 v96, 896, v43
  v_add_u32 v96, v96, v46
  v_lshrrev_b32 v43, 5, v1
  v_and_b32 v44, 31, v1
  v_xor_b32 v44, v44, v43
  v_lshlrev_b32 v44, 4, v44
  v_lshl_add_u32 v2, v43, 9, v44
  v_xor_b32 v3, 32, v2
  v_xor_b32 v4, 64, v2
  v_xor_b32 v5, 96, v2
  v_xor_b32 v6, 4224, v2
  v_xor_b32 v7, 4256, v2
  v_xor_b32 v8, 4288, v2
  v_xor_b32 v9, 4320, v2
  v_and_b32 v43, 15, v1
  v_xor_b32 v44, v43, v45
  v_lshlrev_b32 v44, 4, v44
  v_lshl_add_u32 v44, v43, 9, v44
  v_add_u32 v21, s64, v44
  v_xor_b32 v22, 64, v21
  v_xor_b32 v23, 128, v21
  v_xor_b32 v24, 192, v21
  v_lshlrev_b32 v35, 4, v1
  v_add_u32 v32, 65536, v35
  v_add_u32 v34, 131072, v35
  v_lshrrev_b32 v44, 1, v45
  v_lshl_add_u32 v44, v44, 4, v43
  v_lshlrev_b32 v44, 4, v44
  v_and_b32 v46, 1, v45
  v_lshl_add_u32 v44, v46, 3, v44
  v_add_u32 v31, s65, v44
  s_lshl_b32 s81, s56, 12
  s_add_u32 s81, s81, 147456
  v_add_u32 v41, s81, v44
  s_and_b32 s81, s56, 1
  s_lshr_b32 s82, s56, 1
  s_mul_i32 s82, s82, 6144
  s_lshl3_add_u32 s81, s81, s82
  v_add_u32 v33, s81, v34
  v_lshlrev_b32 v38, 4, v43
  v_mov_b32 v54, 0
  v_mov_b32 v55, 0
  v_mov_b32 v56, 0
  v_mov_b32 v57, 0
  v_mov_b32 v58, 0
  v_mov_b32 v59, 0
  s_lshl3_add_u32 s81, s58, s57
  s_lshl1_add_u32 s81, s81, s60
  s_lshl_b32 s81, s81, 18
  s_and_b32 s82, s81, 4456448
  s_bcnt1_i32_b32 s82, s82
  s_and_b32 s82, s82, 1
  s_lshl_b32 s82, s82, 13
  s_add_u32 s81, s81, s82
  s_lshl_b32 s82, s56, 14
  s_add_u32 s62, s81, s82
  s_lshl_b32 s82, s56, 7
  s_add_u32 s63, s81, s82
  s_mov_b32 s94, 0x3db8aa3b
  s_mov_b32 s93, 0
  s_add_u32 m0, s65, 4096
  s_xor_b32 s6, s74, 262144
  buffer_load_dwordx4 v14, s[20:23], s6 offen lds
  buffer_load_dwordx4 v15, s[20:23], s6 offen offset:1024 lds
  buffer_load_dwordx4 v16, s[20:23], s6 offen offset:2048 lds
  buffer_load_dwordx4 v17, s[20:23], s6 offen offset:3072 lds
  s_mov_b64 exec, 0
  s_cmp_eq_u32 s56, 0
  s_cbranch_scc1 L_it0
  s_cmp_eq_u32 s56, 1
  s_cbranch_scc1 L_it1
  s_cmp_eq_u32 s56, 2
  s_cbranch_scc1 L_it2
  s_branch L_it3
L_itback:
  s_mov_b64 exec, -1
  s_waitcnt vmcnt(4)
  s_add_u32 m0, s66, 12288
  s_nop 0
  buffer_load_dwordx4 v18, s[8:11], s68 offen lds
  buffer_load_dwordx4 v19, s[8:11], s68 offen offset:1024 lds
  buffer_load_dwordx4 v20, s[8:11], s68 offen offset:2048 lds
  s_barrier
  ds_read_b64_tr_b16 a[0:1], v25
  ds_read_b64_tr_b16 a[2:3], v25 offset:2048
  ds_read_b128 a[128:131], v29
  ds_read_b64_tr_b16 a[4:5], v26
  ds_read_b64_tr_b16 a[6:7], v26 offset:2048
  ds_read_b64_tr_b16 a[8:9], v27
  ds_read_b64_tr_b16 a[10:11], v27 offset:2048
  ds_read_b64_tr_b16 a[12:13], v28
  ds_read_b64_tr_b16 a[14:15], v28 offset:2048
  ds_read_b128 a[132:135], v29 offset:2048
  ds_read_b128 a[136:139], v29 offset:4096
  ds_read_b128 a[140:143], v29 offset:6144
  ds_read_b128 a[144:147], v29 offset:8192
  ds_read_b128 a[148:151], v29 offset:10240
  s_add_u32 m0, s65, 8192
  s_waitcnt lgkmcnt(11)
  v_mfma_f32_16x16x32_bf16 v[156:159], a[0:3], a[128:131], 0
  buffer_load_dwordx4 v14, s[20:23], s75 offen lds
  s_waitcnt lgkmcnt(9)
  v_mfma_f32_16x16x32_bf16 v[160:163], a[4:7], a[128:131], 0
  s_waitcnt lgkmcnt(7)
  v_mfma_f32_16x16x32_bf16 v[164:167], a[8:11], a[128:131], 0
  buffer_load_dwordx4 v15, s[20:23], s75 offen offset:1024 lds
  s_waitcnt lgkmcnt(5)
  v_mfma_f32_16x16x32_bf16 v[168:171], a[12:15], a[128:131], 0
  s_waitcnt lgkmcnt(4)
  v_mfma_f32_16x16x32_bf16 v[172:175], a[0:3], a[132:135], 0
  v_mfma_f32_16x16x32_bf16 v[176:179], a[4:7], a[132:135], 0
  s_waitcnt vmcnt(5)
  buffer_load_dwordx4 v16, s[20:23], s75 offen offset:2048 lds
  v_mfma_f32_16x16x32_bf16 v[180:183], a[8:11], a[132:135], 0
  ds_read_b64_tr_b16 a[16:17], v25 offset:4096
  v_mfma_f32_16x16x32_bf16 v[184:187], a[12:15], a[132:135], 0
  ds_read_b64_tr_b16 a[18:19], v25 offset:6144
  s_waitcnt lgkmcnt(5)
  v_mfma_f32_16x16x32_bf16 v[188:191], a[0:3], a[136:139], 0
  buffer_load_dwordx4 v17, s[20:23], s75 offen offset:3072 lds
  s_add_u32 m0, s65, 12288
  v_mfma_f32_16x16x32_bf16 v[192:195], a[4:7], a[136:139], 0
  ds_read_b64_tr_b16 a[20:21], v26 offset:4096
  s_xor_b32 s6, s75, 262144
  v_mfma_f32_16x16x32_bf16 v[196:199], a[8:11], a[136:139], 0
  ds_read_b128 a[152:155], v30
  v_mfma_f32_16x16x32_bf16 v[200:203], a[12:15], a[136:139], 0
  buffer_load_dwordx4 v14, s[20:23], s6 offen lds
  s_waitcnt lgkmcnt(6)
  v_mfma_f32_16x16x32_bf16 v[204:207], a[0:3], a[140:143], 0
  ds_read_b64_tr_b16 a[22:23], v26 offset:6144
  v_mfma_f32_16x16x32_bf16 v[208:211], a[4:7], a[140:143], 0
  ds_read_b128 a[156:159], v30 offset:2048
  v_mfma_f32_16x16x32_bf16 v[212:215], a[8:11], a[140:143], 0
  buffer_load_dwordx4 v15, s[20:23], s6 offen offset:1024 lds
  v_mfma_f32_16x16x32_bf16 v[216:219], a[12:15], a[140:143], 0
  ds_read_b64_tr_b16 a[24:25], v27 offset:4096
  s_waitcnt lgkmcnt(8)
  v_mfma_f32_16x16x32_bf16 v[220:223], a[0:3], a[144:147], 0
  ds_read_b128 a[160:163], v30 offset:4096
  v_mfma_f32_16x16x32_bf16 v[224:227], a[4:7], a[144:147], 0
  buffer_load_dwordx4 v16, s[20:23], s6 offen offset:2048 lds
  v_mfma_f32_16x16x32_bf16 v[228:231], a[8:11], a[144:147], 0
  ds_read_b64_tr_b16 a[26:27], v27 offset:6144
  v_mfma_f32_16x16x32_bf16 v[232:235], a[12:15], a[144:147], 0
  ds_read_b128 a[164:167], v30 offset:6144
  s_waitcnt lgkmcnt(10)
  v_mfma_f32_16x16x32_bf16 v[236:239], a[0:3], a[148:151], 0
  buffer_load_dwordx4 v17, s[20:23], s6 offen offset:3072 lds
  s_add_u32 m0, s66, 24576
  v_mfma_f32_16x16x32_bf16 v[240:243], a[4:7], a[148:151], 0
  ds_read_b64_tr_b16 a[28:29], v28 offset:4096
  ds_read_b64_tr_b16 a[30:31], v28 offset:6144
  ds_read_b128 a[168:171], v30 offset:8192
  ds_read_b128 a[172:175], v30 offset:10240
  v_mfma_f32_16x16x32_bf16 v[244:247], a[8:11], a[148:151], 0
  v_mfma_f32_16x16x32_bf16 v[248:251], a[12:15], a[148:151], 0
  buffer_load_dwordx4 v18, s[8:11], s69 offen lds
  s_waitcnt lgkmcnt(10)
  v_mfma_f32_16x16x32_bf16 v[156:159], a[16:19], a[152:155], v[156:159]
  s_waitcnt lgkmcnt(9)
  v_mfma_f32_16x16x32_bf16 v[160:163], a[20:23], a[152:155], v[160:163]
  buffer_load_dwordx4 v19, s[8:11], s69 offen offset:1024 lds
  s_waitcnt lgkmcnt(5)
  v_mfma_f32_16x16x32_bf16 v[164:167], a[24:27], a[152:155], v[164:167]
  s_waitcnt lgkmcnt(2)
  v_mfma_f32_16x16x32_bf16 v[168:171], a[28:31], a[152:155], v[168:171]
  buffer_load_dwordx4 v20, s[8:11], s69 offen offset:2048 lds
  s_add_u32 m0, s65, 0
  v_mfma_f32_16x16x32_bf16 v[172:175], a[16:19], a[156:159], v[172:175]
  v_mfma_f32_16x16x32_bf16 v[176:179], a[20:23], a[156:159], v[176:179]
  s_waitcnt vmcnt(7)
  s_waitcnt lgkmcnt(0)
  s_barrier
  buffer_load_dwordx4 v14, s[20:23], s76 offen lds
  v_mfma_f32_16x16x32_bf16 v[180:183], a[24:27], a[156:159], v[180:183]
  ds_read_b64_tr_b16 a[32:33], v25 offset:8192
  v_mfma_f32_16x16x32_bf16 v[184:187], a[28:31], a[156:159], v[184:187]
  buffer_load_dwordx4 v15, s[20:23], s76 offen offset:1024 lds
  v_mfma_f32_16x16x32_bf16 v[188:191], a[16:19], a[160:163], v[188:191]
  ds_read_b64_tr_b16 a[34:35], v25 offset:10240
  v_mfma_f32_16x16x32_bf16 v[192:195], a[20:23], a[160:163], v[192:195]
  buffer_load_dwordx4 v16, s[20:23], s76 offen offset:2048 lds
  v_mfma_f32_16x16x32_bf16 v[196:199], a[24:27], a[160:163], v[196:199]
  ds_read_b64_tr_b16 a[36:37], v26 offset:8192
  v_mfma_f32_16x16x32_bf16 v[200:203], a[28:31], a[160:163], v[200:203]
  buffer_load_dwordx4 v17, s[20:23], s76 offen offset:3072 lds
  s_add_u32 m0, s65, 4096
  v_mfma_f32_16x16x32_bf16 v[204:207], a[16:19], a[164:167], v[204:207]
  ds_read_b64_tr_b16 a[38:39], v26 offset:10240
  s_xor_b32 s6, s76, 262144
  v_mfma_f32_16x16x32_bf16 v[208:211], a[20:23], a[164:167], v[208:211]
  ds_read_b64_tr_b16 a[40:41], v27 offset:8192
  ds_read_b64_tr_b16 a[42:43], v27 offset:10240
  ds_read_b64_tr_b16 a[44:45], v28 offset:8192
  ds_read_b64_tr_b16 a[46:47], v28 offset:10240
  v_mfma_f32_16x16x32_bf16 v[212:215], a[24:27], a[164:167], v[212:215]
  buffer_load_dwordx4 v14, s[20:23], s6 offen lds
  v_mfma_f32_16x16x32_bf16 v[216:219], a[28:31], a[164:167], v[216:219]
  ds_read_b128 a[128:131], v29 offset:12288
  v_mfma_f32_16x16x32_bf16 v[220:223], a[16:19], a[168:171], v[220:223]
  s_waitcnt vmcnt(8)
  buffer_load_dwordx4 v15, s[20:23], s6 offen offset:1024 lds
  v_mfma_f32_16x16x32_bf16 v[224:227], a[20:23], a[168:171], v[224:227]
  ds_read_b128 a[132:135], v29 offset:14336
  v_mfma_f32_16x16x32_bf16 v[228:231], a[24:27], a[168:171], v[228:231]
  buffer_load_dwordx4 v16, s[20:23], s6 offen offset:2048 lds
  v_mfma_f32_16x16x32_bf16 v[232:235], a[28:31], a[168:171], v[232:235]
  ds_read_b128 a[136:139], v29 offset:16384
  v_mfma_f32_16x16x32_bf16 v[236:239], a[16:19], a[172:175], v[236:239]
  buffer_load_dwordx4 v17, s[20:23], s6 offen offset:3072 lds
  v_mfma_f32_16x16x32_bf16 v[240:243], a[20:23], a[172:175], v[240:243]
  ds_read_b128 a[140:143], v29 offset:18432
  ds_read_b128 a[144:147], v29 offset:20480
  ds_read_b128 a[148:151], v29 offset:22528
  v_mfma_f32_16x16x32_bf16 v[244:247], a[24:27], a[172:175], v[244:247]
  ds_read_b64_tr_b16 a[48:49], v25 offset:12288
  s_add_u32 m0, s66, 36864
  v_mfma_f32_16x16x32_bf16 v[248:251], a[28:31], a[172:175], v[248:251]
  ds_read_b64_tr_b16 a[50:51], v25 offset:14336
  s_waitcnt lgkmcnt(7)
  v_mfma_f32_16x16x32_bf16 v[156:159], a[32:35], a[128:131], v[156:159]
  ds_read_b64_tr_b16 a[52:53], v26 offset:12288
  v_mfma_f32_16x16x32_bf16 v[160:163], a[36:39], a[128:131], v[160:163]
  buffer_load_dwordx4 v18, s[8:11], s70 offen lds
  v_mfma_f32_16x16x32_bf16 v[164:167], a[40:43], a[128:131], v[164:167]
  ds_read_b64_tr_b16 a[54:55], v26 offset:14336
  v_mfma_f32_16x16x32_bf16 v[168:171], a[44:47], a[128:131], v[168:171]
  buffer_load_dwordx4 v19, s[8:11], s70 offen offset:1024 lds
  s_waitcnt lgkmcnt(8)
  v_mfma_f32_16x16x32_bf16 v[172:175], a[32:35], a[132:135], v[172:175]
  ds_read_b64_tr_b16 a[56:57], v27 offset:12288
  ds_read_b64_tr_b16 a[58:59], v27 offset:14336
  ds_read_b64_tr_b16 a[60:61], v28 offset:12288
  ds_read_b64_tr_b16 a[62:63], v28 offset:14336
  v_mfma_f32_16x16x32_bf16 v[176:179], a[36:39], a[132:135], v[176:179]
  buffer_load_dwordx4 v20, s[8:11], s70 offen offset:2048 lds
  s_add_u32 m0, s65, 8192
  v_mfma_f32_16x16x32_bf16 v[180:183], a[40:43], a[132:135], v[180:183]
  ds_read_b128 a[152:155], v30 offset:12288
  v_mfma_f32_16x16x32_bf16 v[184:187], a[44:47], a[132:135], v[184:187]
  s_waitcnt vmcnt(7)
  buffer_load_dwordx4 v14, s[20:23], s77 offen lds
  s_waitcnt lgkmcnt(12)
  v_mfma_f32_16x16x32_bf16 v[188:191], a[32:35], a[136:139], v[188:191]
  ds_read_b64_tr_b16 a[64:65], v25
  v_mfma_f32_16x16x32_bf16 v[192:195], a[36:39], a[136:139], v[192:195]
  buffer_load_dwordx4 v15, s[20:23], s77 offen offset:1024 lds
  v_mfma_f32_16x16x32_bf16 v[196:199], a[40:43], a[136:139], v[196:199]
  ds_read_b64_tr_b16 a[66:67], v25 offset:2048
  v_mfma_f32_16x16x32_bf16 v[200:203], a[44:47], a[136:139], v[200:203]
  buffer_load_dwordx4 v16, s[20:23], s77 offen offset:2048 lds
  s_waitcnt lgkmcnt(13)
  v_mfma_f32_16x16x32_bf16 v[204:207], a[32:35], a[140:143], v[204:207]
  ds_read_b64_tr_b16 a[68:69], v26
  v_mfma_f32_16x16x32_bf16 v[208:211], a[36:39], a[140:143], v[208:211]
  buffer_load_dwordx4 v17, s[20:23], s77 offen offset:3072 lds
  s_add_u32 m0, s65, 12288
  v_mfma_f32_16x16x32_bf16 v[212:215], a[40:43], a[140:143], v[212:215]
  ds_read_b64_tr_b16 a[70:71], v26 offset:2048
  s_xor_b32 s6, s77, 262144
  v_mfma_f32_16x16x32_bf16 v[216:219], a[44:47], a[140:143], v[216:219]
  s_waitcnt lgkmcnt(5)
  buffer_load_dwordx4 v14, s[20:23], s6 offen lds
  v_mfma_f32_16x16x32_bf16 v[220:223], a[32:35], a[144:147], v[220:223]
  ds_read_b64_tr_b16 a[72:73], v27
  v_mfma_f32_16x16x32_bf16 v[224:227], a[36:39], a[144:147], v[224:227]
  buffer_load_dwordx4 v15, s[20:23], s6 offen offset:1024 lds
  v_mfma_f32_16x16x32_bf16 v[228:231], a[40:43], a[144:147], v[228:231]
  ds_read_b64_tr_b16 a[74:75], v27 offset:2048
  v_mfma_f32_16x16x32_bf16 v[232:235], a[44:47], a[144:147], v[232:235]
  buffer_load_dwordx4 v16, s[20:23], s6 offen offset:2048 lds
  v_mfma_f32_16x16x32_bf16 v[236:239], a[32:35], a[148:151], v[236:239]
  ds_read_b128 a[156:159], v30 offset:14336
  ds_read_b64_tr_b16 a[76:77], v28
  ds_read_b64_tr_b16 a[78:79], v28 offset:2048
  v_mfma_f32_16x16x32_bf16 v[240:243], a[36:39], a[148:151], v[240:243]
  buffer_load_dwordx4 v17, s[20:23], s6 offen offset:3072 lds
  s_add_u32 m0, s66, 49152
  ds_read_b128 a[160:163], v30 offset:16384
  ds_read_b128 a[164:167], v30 offset:18432
  ds_read_b128 a[168:171], v30 offset:20480
  ds_read_b128 a[172:175], v30 offset:22528
  v_mfma_f32_16x16x32_bf16 v[244:247], a[40:43], a[148:151], v[244:247]
  v_mfma_f32_16x16x32_bf16 v[248:251], a[44:47], a[148:151], v[248:251]
  s_waitcnt vmcnt(11)
  ds_read_b64_tr_b16 a[80:81], v25 offset:4096
  s_waitcnt lgkmcnt(14)
  v_mfma_f32_16x16x32_bf16 v[156:159], a[48:51], a[152:155], v[156:159]
  s_waitcnt lgkmcnt(1)
  s_barrier
  buffer_load_dwordx4 v18, s[8:11], s71 offen lds
  v_mfma_f32_16x16x32_bf16 v[160:163], a[52:55], a[152:155], v[160:163]
  ds_read_b64_tr_b16 a[82:83], v25 offset:6144
  v_mfma_f32_16x16x32_bf16 v[164:167], a[56:59], a[152:155], v[164:167]
  buffer_load_dwordx4 v19, s[8:11], s71 offen offset:1024 lds
  v_mfma_f32_16x16x32_bf16 v[168:171], a[60:63], a[152:155], v[168:171]
  ds_read_b64_tr_b16 a[84:85], v26 offset:4096
  v_mfma_f32_16x16x32_bf16 v[172:175], a[48:51], a[156:159], v[172:175]
  ds_read_b64_tr_b16 a[86:87], v26 offset:6144
  v_mfma_f32_16x16x32_bf16 v[176:179], a[52:55], a[156:159], v[176:179]
  buffer_load_dwordx4 v20, s[8:11], s71 offen offset:2048 lds
  s_add_u32 m0, s65, 0
  v_mfma_f32_16x16x32_bf16 v[180:183], a[56:59], a[156:159], v[180:183]
  ds_read_b64_tr_b16 a[88:89], v27 offset:4096
  v_mfma_f32_16x16x32_bf16 v[184:187], a[60:63], a[156:159], v[184:187]
  ds_read_b64_tr_b16 a[90:91], v27 offset:6144
  v_mfma_f32_16x16x32_bf16 v[188:191], a[48:51], a[160:163], v[188:191]
  buffer_load_dwordx4 v14, s[20:23], s78 offen lds
  v_mfma_f32_16x16x32_bf16 v[192:195], a[52:55], a[160:163], v[192:195]
  ds_read_b64_tr_b16 a[92:93], v28 offset:4096
  v_mfma_f32_16x16x32_bf16 v[196:199], a[56:59], a[160:163], v[196:199]
  buffer_load_dwordx4 v15, s[20:23], s78 offen offset:1024 lds
  v_mfma_f32_16x16x32_bf16 v[200:203], a[60:63], a[160:163], v[200:203]
  ds_read_b64_tr_b16 a[94:95], v28 offset:6144
  v_mfma_f32_16x16x32_bf16 v[204:207], a[48:51], a[164:167], v[204:207]
  ds_read_b128 a[128:131], v29 offset:24576
  v_mfma_f32_16x16x32_bf16 v[208:211], a[52:55], a[164:167], v[208:211]
  buffer_load_dwordx4 v16, s[20:23], s78 offen offset:2048 lds
  v_mfma_f32_16x16x32_bf16 v[212:215], a[56:59], a[164:167], v[212:215]
  s_waitcnt vmcnt(10)
  ds_read_b128 a[132:135], v29 offset:26624
  v_mfma_f32_16x16x32_bf16 v[216:219], a[60:63], a[164:167], v[216:219]
  ds_read_b128 a[136:139], v29 offset:28672
  v_mfma_f32_16x16x32_bf16 v[220:223], a[48:51], a[168:171], v[220:223]
  buffer_load_dwordx4 v17, s[20:23], s78 offen offset:3072 lds
  s_add_u32 m0, s65, 4096
  v_mfma_f32_16x16x32_bf16 v[224:227], a[52:55], a[168:171], v[224:227]
  ds_read_b128 a[140:143], v29 offset:30720
  s_xor_b32 s6, s78, 262144
  v_mfma_f32_16x16x32_bf16 v[228:231], a[56:59], a[168:171], v[228:231]
  ds_read_b128 a[144:147], v29 offset:32768
  v_mfma_f32_16x16x32_bf16 v[232:235], a[60:63], a[168:171], v[232:235]
  s_waitcnt lgkmcnt(5)
  buffer_load_dwordx4 v14, s[20:23], s6 offen lds
  v_mfma_f32_16x16x32_bf16 v[236:239], a[48:51], a[172:175], v[236:239]
  ds_read_b128 a[148:151], v29 offset:34816
  v_mfma_f32_16x16x32_bf16 v[240:243], a[52:55], a[172:175], v[240:243]
  ds_read_b64_tr_b16 a[96:97], v25 offset:8192
  v_mfma_f32_16x16x32_bf16 v[244:247], a[56:59], a[172:175], v[244:247]
  buffer_load_dwordx4 v15, s[20:23], s6 offen offset:1024 lds
  v_mfma_f32_16x16x32_bf16 v[248:251], a[60:63], a[172:175], v[248:251]
  ds_read_b64_tr_b16 a[98:99], v25 offset:10240
  s_waitcnt lgkmcnt(7)
  v_mfma_f32_16x16x32_bf16 v[156:159], a[64:67], a[128:131], v[156:159]
L_it0:
  s_cbranch_execz L_it4
  ds_read_b64_tr_b16 a[100:101], v26 offset:8192
  v_mfma_f32_16x16x32_bf16 v[160:163], a[68:71], a[128:131], v[160:163]
  buffer_load_dwordx4 v16, s[20:23], s6 offen offset:2048 lds
  v_mfma_f32_16x16x32_bf16 v[164:167], a[72:75], a[128:131], v[164:167]
  ds_read_b64_tr_b16 a[102:103], v26 offset:10240
  v_mfma_f32_16x16x32_bf16 v[168:171], a[76:79], a[128:131], v[168:171]
  ds_read_b64_tr_b16 a[104:105], v27 offset:8192
  ds_read_b64_tr_b16 a[106:107], v27 offset:10240
  ds_read_b64_tr_b16 a[108:109], v28 offset:8192
  ds_read_b64_tr_b16 a[110:111], v28 offset:10240
  s_waitcnt lgkmcnt(12)
  v_mfma_f32_16x16x32_bf16 v[172:175], a[64:67], a[132:135], v[172:175]
  buffer_load_dwordx4 v17, s[20:23], s6 offen offset:3072 lds
  s_add_u32 m0, s66, 143360
  v_mfma_f32_16x16x32_bf16 v[176:179], a[68:71], a[132:135], v[176:179]
  ds_read_b128 a[152:155], v30 offset:24576
  v_mfma_f32_16x16x32_bf16 v[180:183], a[72:75], a[132:135], v[180:183]
  s_waitcnt vmcnt(11)
  ds_read_b64_tr_b16 a[112:113], v25 offset:12288
  v_mfma_f32_16x16x32_bf16 v[184:187], a[76:79], a[132:135], v[184:187]
  buffer_load_dwordx4 v18, s[8:11], s72 offen lds
  s_waitcnt lgkmcnt(13)
  v_mfma_f32_16x16x32_bf16 v[188:191], a[64:67], a[136:139], v[188:191]
  ds_read_b64_tr_b16 a[114:115], v25 offset:14336
  v_mfma_f32_16x16x32_bf16 v[192:195], a[68:71], a[136:139], v[192:195]
  buffer_load_dwordx4 v19, s[8:11], s72 offen offset:1024 lds
  v_mfma_f32_16x16x32_bf16 v[196:199], a[72:75], a[136:139], v[196:199]
  ds_read_b64_tr_b16 a[116:117], v26 offset:12288
  v_mfma_f32_16x16x32_bf16 v[200:203], a[76:79], a[136:139], v[200:203]
  ds_read_b64_tr_b16 a[118:119], v26 offset:14336
  s_waitcnt lgkmcnt(15)
  v_mfma_f32_16x16x32_bf16 v[204:207], a[64:67], a[140:143], v[204:207]
  buffer_load_dwordx4 v20, s[8:11], s72 offen offset:2048 lds
  s_add_u32 m0, s65, 8192
  v_mfma_f32_16x16x32_bf16 v[208:211], a[68:71], a[140:143], v[208:211]
  ds_read_b64_tr_b16 a[120:121], v27 offset:12288
  v_mfma_f32_16x16x32_bf16 v[212:215], a[72:75], a[140:143], v[212:215]
  ds_read_b64_tr_b16 a[122:123], v27 offset:14336
  v_mfma_f32_16x16x32_bf16 v[216:219], a[76:79], a[140:143], v[216:219]
  s_waitcnt lgkmcnt(7)
  buffer_load_dwordx4 v14, s[20:23], s79 offen lds
  v_mfma_f32_16x16x32_bf16 v[220:223], a[64:67], a[144:147], v[220:223]
  ds_read_b64_tr_b16 a[124:125], v28 offset:12288
  v_mfma_f32_16x16x32_bf16 v[224:227], a[68:71], a[144:147], v[224:227]
  buffer_load_dwordx4 v15, s[20:23], s79 offen offset:1024 lds
  v_mfma_f32_16x16x32_bf16 v[228:231], a[72:75], a[144:147], v[228:231]
  ds_read_b64_tr_b16 a[126:127], v28 offset:14336
  v_mfma_f32_16x16x32_bf16 v[232:235], a[76:79], a[144:147], v[232:235]
  ds_read_b128 a[156:159], v30 offset:26624
  v_mfma_f32_16x16x32_bf16 v[236:239], a[64:67], a[148:151], v[236:239]
  buffer_load_dwordx4 v16, s[20:23], s79 offen offset:2048 lds
  v_mfma_f32_16x16x32_bf16 v[240:243], a[68:71], a[148:151], v[240:243]
  s_waitcnt vmcnt(10)
  ds_read_b128 a[160:163], v30 offset:28672
  ds_read_b128 a[164:167], v30 offset:30720
  ds_read_b128 a[168:171], v30 offset:32768
  ds_read_b128 a[172:175], v30 offset:34816
  v_mfma_f32_16x16x32_bf16 v[244:247], a[72:75], a[148:151], v[244:247]
  ds_read_b64_tr_b16 a[0:1], v25
  v_mfma_f32_16x16x32_bf16 v[248:251], a[76:79], a[148:151], v[248:251]
  buffer_load_dwordx4 v17, s[20:23], s79 offen offset:3072 lds
  s_add_u32 m0, s65, 12288
  s_waitcnt lgkmcnt(14)
  v_mfma_f32_16x16x32_bf16 v[156:159], a[80:83], a[152:155], v[156:159]
  s_waitcnt lgkmcnt(1)
  s_barrier
  ds_read_b64_tr_b16 a[2:3], v25 offset:2048
  s_xor_b32 s6, s79, 262144
  v_mfma_f32_16x16x32_bf16 v[160:163], a[84:87], a[152:155], v[160:163]
  ds_read_b64_tr_b16 a[4:5], v26
  v_mfma_f32_16x16x32_bf16 v[164:167], a[88:91], a[152:155], v[164:167]
  buffer_load_dwordx4 v14, s[20:23], s6 offen lds
  v_mfma_f32_16x16x32_bf16 v[168:171], a[92:95], a[152:155], v[168:171]
  ds_read_b64_tr_b16 a[6:7], v26 offset:2048
  v_mfma_f32_16x16x32_bf16 v[172:175], a[80:83], a[156:159], v[172:175]
  buffer_load_dwordx4 v15, s[20:23], s6 offen offset:1024 lds
  v_mfma_f32_16x16x32_bf16 v[176:179], a[84:87], a[156:159], v[176:179]
  ds_read_b64_tr_b16 a[8:9], v27
  v_mfma_f32_16x16x32_bf16 v[180:183], a[88:91], a[156:159], v[180:183]
  ds_read_b64_tr_b16 a[10:11], v27 offset:2048
  v_mfma_f32_16x16x32_bf16 v[184:187], a[92:95], a[156:159], v[184:187]
  buffer_load_dwordx4 v16, s[20:23], s6 offen offset:2048 lds
  v_mfma_f32_16x16x32_bf16 v[188:191], a[80:83], a[160:163], v[188:191]
  ds_read_b64_tr_b16 a[12:13], v28
  v_mfma_f32_16x16x32_bf16 v[192:195], a[84:87], a[160:163], v[192:195]
  ds_read_b64_tr_b16 a[14:15], v28 offset:2048
  v_mfma_f32_16x16x32_bf16 v[196:199], a[88:91], a[160:163], v[196:199]
  buffer_load_dwordx4 v17, s[20:23], s6 offen offset:3072 lds
  s_add_u32 m0, s66, 131072
  v_mfma_f32_16x16x32_bf16 v[200:203], a[92:95], a[160:163], v[200:203]
  ds_read_b128 a[128:131], v29 offset:36864
  v_mfma_f32_16x16x32_bf16 v[204:207], a[80:83], a[164:167], v[204:207]
  s_waitcnt vmcnt(11)
  ds_read_b128 a[132:135], v29 offset:38912
  v_mfma_f32_16x16x32_bf16 v[208:211], a[84:87], a[164:167], v[208:211]
  buffer_load_dwordx4 v18, s[8:11], s73 offen lds
  v_mfma_f32_16x16x32_bf16 v[212:215], a[88:91], a[164:167], v[212:215]
  ds_read_b128 a[136:139], v29 offset:40960
  v_mfma_f32_16x16x32_bf16 v[216:219], a[92:95], a[164:167], v[216:219]
  ds_read_b128 a[140:143], v29 offset:43008
  v_mfma_f32_16x16x32_bf16 v[220:223], a[80:83], a[168:171], v[220:223]
  ds_read_b128 a[144:147], v29 offset:45056
  v_mfma_f32_16x16x32_bf16 v[224:227], a[84:87], a[168:171], v[224:227]
  buffer_load_dwordx4 v19, s[8:11], s73 offen offset:1024 lds
  v_mfma_f32_16x16x32_bf16 v[228:231], a[88:91], a[168:171], v[228:231]
  ds_read_b128 a[148:151], v29 offset:47104
  v_mfma_f32_16x16x32_bf16 v[232:235], a[92:95], a[168:171], v[232:235]
  ds_read_b64_tr_b16 a[16:17], v25 offset:4096
  v_mfma_f32_16x16x32_bf16 v[236:239], a[80:83], a[172:175], v[236:239]
  ds_read_b64_tr_b16 a[18:19], v25 offset:6144
  v_mfma_f32_16x16x32_bf16 v[240:243], a[84:87], a[172:175], v[240:243]
  buffer_load_dwordx4 v20, s[8:11], s73 offen offset:2048 lds
  v_mfma_f32_16x16x32_bf16 v[244:247], a[88:91], a[172:175], v[244:247]
  ds_read_b64_tr_b16 a[20:21], v26 offset:4096
  v_mfma_f32_16x16x32_bf16 v[248:251], a[92:95], a[172:175], v[248:251]
  ds_read_b64_tr_b16 a[22:23], v26 offset:6144
  s_add_u32 m0, s65, 0
  s_waitcnt lgkmcnt(9)
  v_mfma_f32_16x16x32_bf16 v[156:159], a[96:99], a[128:131], v[156:159]
  ds_read_b64_tr_b16 a[24:25], v27 offset:4096
  v_mfma_f32_16x16x32_bf16 v[160:163], a[100:103], a[128:131], v[160:163]
  ds_read_b64_tr_b16 a[26:27], v27 offset:6144
  v_mfma_f32_16x16x32_bf16 v[164:167], a[104:107], a[128:131], v[164:167]
  buffer_load_dwordx4 v14, s[20:23], s80 offen lds
  v_mfma_f32_16x16x32_bf16 v[168:171], a[108:111], a[128:131], v[168:171]
  ds_read_b64_tr_b16 a[28:29], v28 offset:4096
  s_waitcnt lgkmcnt(11)
  v_mfma_f32_16x16x32_bf16 v[172:175], a[96:99], a[132:135], v[172:175]
  ds_read_b64_tr_b16 a[30:31], v28 offset:6144
  v_mfma_f32_16x16x32_bf16 v[176:179], a[100:103], a[132:135], v[176:179]
  ds_read_b128 a[152:155], v30 offset:36864
  v_mfma_f32_16x16x32_bf16 v[180:183], a[104:107], a[132:135], v[180:183]
  buffer_load_dwordx4 v15, s[20:23], s80 offen offset:1024 lds
  v_mfma_f32_16x16x32_bf16 v[184:187], a[108:111], a[132:135], v[184:187]
  ds_read_b128 a[156:159], v30 offset:38912
  s_waitcnt lgkmcnt(13)
  v_mfma_f32_16x16x32_bf16 v[188:191], a[96:99], a[136:139], v[188:191]
  ds_read_b128 a[160:163], v30 offset:40960
  v_mfma_f32_16x16x32_bf16 v[192:195], a[100:103], a[136:139], v[192:195]
  ds_read_b128 a[164:167], v30 offset:43008
  v_mfma_f32_16x16x32_bf16 v[196:199], a[104:107], a[136:139], v[196:199]
  buffer_load_dwordx4 v16, s[20:23], s80 offen offset:2048 lds
  v_mfma_f32_16x16x32_bf16 v[200:203], a[108:111], a[136:139], v[200:203]
  s_waitcnt lgkmcnt(14)
  v_mfma_f32_16x16x32_bf16 v[204:207], a[96:99], a[140:143], v[204:207]
  s_waitcnt vmcnt(10)
  ds_read_b128 a[168:171], v30 offset:45056
  v_mfma_f32_16x16x32_bf16 v[208:211], a[100:103], a[140:143], v[208:211]
  ds_read_b64_tr_b16 a[32:33], v25 offset:8192
  v_mfma_f32_16x16x32_bf16 v[212:215], a[104:107], a[140:143], v[212:215]
  buffer_load_dwordx4 v17, s[20:23], s80 offen offset:3072 lds
  v_mfma_f32_16x16x32_bf16 v[216:219], a[108:111], a[140:143], v[216:219]
  ds_read_b128 a[172:175], v30 offset:47104
  s_waitcnt lgkmcnt(15)
  v_mfma_f32_16x16x32_bf16 v[220:223], a[96:99], a[144:147], v[220:223]
  ds_read_b64_tr_b16 a[34:35], v25 offset:10240
  s_add_u32 m0, s65, 4096
  v_mfma_f32_16x16x32_bf16 v[224:227], a[100:103], a[144:147], v[224:227]
  ds_read_b64_tr_b16 a[36:37], v26 offset:8192
  s_xor_b32 s6, s80, 262144
  v_mfma_f32_16x16x32_bf16 v[228:231], a[104:107], a[144:147], v[228:231]
  v_mfma_f32_16x16x32_bf16 v[232:235], a[108:111], a[144:147], v[232:235]
  s_waitcnt lgkmcnt(9)
  buffer_load_dwordx4 v14, s[20:23], s6 offen lds
  v_mfma_f32_16x16x32_bf16 v[236:239], a[96:99], a[148:151], v[236:239]
  ds_read_b64_tr_b16 a[38:39], v26 offset:10240
  v_mfma_f32_16x16x32_bf16 v[240:243], a[100:103], a[148:151], v[240:243]
  ds_read_b64_tr_b16 a[40:41], v27 offset:8192
  v_mfma_f32_16x16x32_bf16 v[244:247], a[104:107], a[148:151], v[244:247]
  v_mfma_f32_16x16x32_bf16 v[248:251], a[108:111], a[148:151], v[248:251]
  buffer_load_dwordx4 v15, s[20:23], s6 offen offset:1024 lds
  s_waitcnt lgkmcnt(10)
  v_mfma_f32_16x16x32_bf16 v[156:159], a[112:115], a[152:155], v[156:159]
  s_waitcnt lgkmcnt(4)
  s_barrier
  ds_read_b64_tr_b16 a[42:43], v27 offset:10240
  s_lshl_b32 s82, s58, 2
  v_mfma_f32_16x16x32_bf16 v[160:163], a[116:119], a[152:155], v[160:163]
  ds_read_b128 a[128:131], v29 offset:49152
  s_and_b32 s95, s2, 31
  v_mfma_f32_16x16x32_bf16 v[164:167], a[120:123], a[152:155], v[164:167]
  s_or_b32 s95, s95, s56
  s_cselect_b32 s82, 256, s82
  ds_read_b64_tr_b16 a[44:45], v28 offset:8192
  v_mfma_f32_16x16x32_bf16 v[168:171], a[124:127], a[152:155], v[168:171]
  ds_read_b128 a[132:135], v29 offset:51200
  v_mfma_f32_16x16x32_bf16 v[172:175], a[112:115], a[156:159], v[172:175]
  buffer_load_dwordx4 v16, s[20:23], s6 offen offset:2048 lds
  v_mfma_f32_16x16x32_bf16 v[176:179], a[116:119], a[156:159], v[176:179]
  ds_read_b64_tr_b16 a[46:47], v28 offset:10240
  v_mfma_f32_16x16x32_bf16 v[180:183], a[120:123], a[156:159], v[180:183]
  ds_read_b128 a[136:139], v29 offset:53248
  v_mfma_f32_16x16x32_bf16 v[184:187], a[124:127], a[156:159], v[184:187]
  ds_read_b128 a[152:155], v30 offset:49152
  v_mov_b32 v39, 1
  v_mfma_f32_16x16x32_bf16 v[188:191], a[112:115], a[160:163], v[188:191]
  buffer_load_dwordx4 v17, s[20:23], s6 offen offset:3072 lds
  v_mfma_f32_16x16x32_bf16 v[192:195], a[116:119], a[160:163], v[192:195]
  ds_read_b128 a[140:143], v29 offset:55296
  v_mfma_f32_16x16x32_bf16 v[196:199], a[120:123], a[160:163], v[196:199]
  v_mfma_f32_16x16x32_bf16 v[200:203], a[124:127], a[160:163], v[200:203]
  v_mfma_f32_16x16x32_bf16 v[204:207], a[112:115], a[164:167], v[204:207]
  s_waitcnt vmcnt(11)
  ds_read_b128 a[144:147], v29 offset:57344
  s_add_u32 m0, s64, 0
  v_mfma_f32_16x16x32_bf16 v[208:211], a[116:119], a[164:167], v[208:211]
  ds_read_b128 a[156:159], v30 offset:51200
  s_xor_b32 s6, s62, 0
  v_mfma_f32_16x16x32_bf16 v[212:215], a[120:123], a[164:167], v[212:215]
  ds_read_b64_tr_b16 a[48:49], v25 offset:12288
  v_mov_b32 v44, s82
  v_mfma_f32_16x16x32_bf16 v[216:219], a[124:127], a[164:167], v[216:219]
  buffer_load_dwordx4 v2, s[12:15], s6 offen nt lds
  v_mfma_f32_16x16x32_bf16 v[220:223], a[112:115], a[168:171], v[220:223]
  ds_read_b128 a[148:151], v29 offset:59392
  v_mfma_f32_16x16x32_bf16 v[224:227], a[116:119], a[168:171], v[224:227]
  ds_read_b64_tr_b16 a[50:51], v25 offset:14336
  v_mfma_f32_16x16x32_bf16 v[228:231], a[120:123], a[168:171], v[228:231]
  ds_read_b64_tr_b16 a[52:53], v26 offset:12288
  v_mfma_f32_16x16x32_bf16 v[232:235], a[124:127], a[168:171], v[232:235]
  ds_read_b64_tr_b16 a[54:55], v26 offset:14336
  v_mfma_f32_16x16x32_bf16 v[236:239], a[112:115], a[172:175], v[236:239]
  ds_read_b128 a[160:163], v30 offset:53248
  v_mfma_f32_16x16x32_bf16 v[240:243], a[116:119], a[172:175], v[240:243]
  buffer_load_dwordx4 v3, s[12:15], s6 offen offset:1024 nt lds
  v_mfma_f32_16x16x32_bf16 v[244:247], a[120:123], a[172:175], v[244:247]
  ds_read_b64_tr_b16 a[56:57], v27 offset:12288
  v_mfma_f32_16x16x32_bf16 v[248:251], a[124:127], a[172:175], v[248:251]
  ds_read_b64_tr_b16 a[58:59], v27 offset:14336
  s_waitcnt lgkmcnt(15)
  v_mfma_f32_16x16x32_bf16 v[156:159], a[0:3], a[128:131], v[156:159]
  ds_read_b128 a[164:167], v30 offset:55296
  s_waitcnt lgkmcnt(12)
  v_mfma_f32_16x16x32_bf16 v[156:159], a[16:19], a[152:155], v[156:159]
  v_mfma_f32_16x16x32_bf16 v[160:163], a[4:7], a[128:131], v[160:163]
  ds_read_b64_tr_b16 a[60:61], v28 offset:12288
  v_mfma_f32_16x16x32_bf16 v[160:163], a[20:23], a[152:155], v[160:163]
  ds_read_b128 a[168:171], v30 offset:57344
  v_mfma_f32_16x16x32_bf16 v[164:167], a[8:11], a[128:131], v[164:167]
  buffer_load_dwordx4 v4, s[12:15], s6 offen offset:2048 nt lds
  v_mfma_f32_16x16x32_bf16 v[164:167], a[24:27], a[152:155], v[164:167]
  ds_read_b64_tr_b16 a[62:63], v28 offset:14336
  v_mfma_f32_16x16x32_bf16 v[168:171], a[12:15], a[128:131], v[168:171]
  buffer_store_dword v39, v44, s[36:39], 0 offen sc1
  v_mfma_f32_16x16x32_bf16 v[168:171], a[28:31], a[152:155], v[168:171]
  v_mfma_f32_16x16x32_bf16 v[172:175], a[0:3], a[132:135], v[172:175]
  ds_read_b128 a[172:175], v30 offset:59392
  s_waitcnt lgkmcnt(13)
  v_mfma_f32_16x16x32_bf16 v[172:175], a[16:19], a[156:159], v[172:175]
  v_mfma_f32_16x16x32_bf16 v[176:179], a[4:7], a[132:135], v[176:179]
  v_mfma_f32_16x16x32_bf16 v[176:179], a[20:23], a[156:159], v[176:179]
  buffer_load_dwordx4 v5, s[12:15], s6 offen offset:3072 nt lds
  v_mfma_f32_16x16x32_bf16 v[180:183], a[8:11], a[132:135], v[180:183]
  s_waitcnt vmcnt(9)
  ds_read_b64_tr_b16 a[64:65], v25
  v_mfma_f32_16x16x32_bf16 v[180:183], a[24:27], a[156:159], v[180:183]
  v_mfma_f32_16x16x32_bf16 v[184:187], a[12:15], a[132:135], v[184:187]
  ds_read_b64_tr_b16 a[66:67], v25 offset:2048
  v_mfma_f32_16x16x32_bf16 v[184:187], a[28:31], a[156:159], v[184:187]
  s_add_u32 m0, s64, 4096
  v_mfma_f32_16x16x32_bf16 v[188:191], a[0:3], a[136:139], v[188:191]
  ds_read_b64_tr_b16 a[68:69], v26
  s_waitcnt lgkmcnt(10)
  v_mfma_f32_16x16x32_bf16 v[188:191], a[16:19], a[160:163], v[188:191]
  v_mfma_f32_16x16x32_bf16 v[192:195], a[4:7], a[136:139], v[192:195]
  buffer_load_dwordx4 v6, s[12:15], s6 offen nt lds
  v_mfma_f32_16x16x32_bf16 v[192:195], a[20:23], a[160:163], v[192:195]
  ds_read_b64_tr_b16 a[70:71], v26 offset:2048
  v_mfma_f32_16x16x32_bf16 v[196:199], a[8:11], a[136:139], v[196:199]
  v_add_u32 v29, 131072, v29
  v_add_u32 v30, 131072, v30
  v_mfma_f32_16x16x32_bf16 v[196:199], a[24:27], a[160:163], v[196:199]
  ds_read_b64_tr_b16 a[72:73], v27
  v_mfma_f32_16x16x32_bf16 v[200:203], a[12:15], a[136:139], v[200:203]
  v_mfma_f32_16x16x32_bf16 v[200:203], a[28:31], a[160:163], v[200:203]
  ds_read_b64_tr_b16 a[74:75], v27 offset:2048
  v_mfma_f32_16x16x32_bf16 v[204:207], a[0:3], a[140:143], v[204:207]
  s_waitcnt lgkmcnt(6)
  s_barrier
  buffer_load_dwordx4 v7, s[12:15], s6 offen offset:1024 nt lds
  v_mfma_f32_16x16x32_bf16 v[204:207], a[16:19], a[164:167], v[204:207]
  ds_read_b128 a[128:131], v29 offset:12288
  v_mfma_f32_16x16x32_bf16 v[208:211], a[4:7], a[140:143], v[208:211]
  ds_read_b64_tr_b16 a[76:77], v28
  v_mfma_f32_16x16x32_bf16 v[208:211], a[20:23], a[164:167], v[208:211]
  ds_read_b128 a[152:155], v30 offset:12288
  v_mfma_f32_16x16x32_bf16 v[212:215], a[8:11], a[140:143], v[212:215]
  ds_read_b64_tr_b16 a[78:79], v28 offset:2048
  v_mfma_f32_16x16x32_bf16 v[212:215], a[24:27], a[164:167], v[212:215]
  ds_read_b128 a[132:135], v29 offset:14336
  v_mfma_f32_16x16x32_bf16 v[216:219], a[12:15], a[140:143], v[216:219]
  ds_read_b128 a[156:159], v30 offset:14336
  v_mfma_f32_16x16x32_bf16 v[216:219], a[28:31], a[164:167], v[216:219]
  buffer_load_dwordx4 v8, s[12:15], s6 offen offset:2048 nt lds
  v_mfma_f32_16x16x32_bf16 v[220:223], a[0:3], a[144:147], v[220:223]
  ds_read_b128 a[136:139], v29 offset:16384
  v_mfma_f32_16x16x32_bf16 v[220:223], a[16:19], a[168:171], v[220:223]
  ds_read_b128 a[160:163], v30 offset:16384
  v_mfma_f32_16x16x32_bf16 v[224:227], a[4:7], a[144:147], v[224:227]
  ds_read_b128 a[140:143], v29 offset:18432
  v_mfma_f32_16x16x32_bf16 v[224:227], a[20:23], a[168:171], v[224:227]
  ds_read_b128 a[164:167], v30 offset:18432
  v_mfma_f32_16x16x32_bf16 v[228:231], a[8:11], a[144:147], v[228:231]
  s_waitcnt vmcnt(8)
  ds_read_b64_tr_b16 a[80:81], v25 offset:4096
  v_mfma_f32_16x16x32_bf16 v[228:231], a[24:27], a[168:171], v[228:231]
  v_mfma_f32_16x16x32_bf16 v[232:235], a[12:15], a[144:147], v[232:235]
  buffer_load_dwordx4 v9, s[12:15], s6 offen offset:3072 nt lds
  v_mfma_f32_16x16x32_bf16 v[232:235], a[28:31], a[168:171], v[232:235]
  ds_read_b64_tr_b16 a[82:83], v25 offset:6144
  v_mfma_f32_16x16x32_bf16 v[236:239], a[0:3], a[148:151], v[236:239]
  ds_read_b64_tr_b16 a[84:85], v26 offset:4096
  v_mfma_f32_16x16x32_bf16 v[236:239], a[16:19], a[172:175], v[236:239]
  ds_read_b128 a[144:147], v29 offset:20480
  v_mfma_f32_16x16x32_bf16 v[240:243], a[4:7], a[148:151], v[240:243]
  ds_read_b128 a[168:171], v30 offset:20480
  s_add_u32 m0, s64, 32768
  v_mfma_f32_16x16x32_bf16 v[240:243], a[20:23], a[172:175], v[240:243]
  ds_read_b64_tr_b16 a[86:87], v26 offset:6144
  s_xor_b32 s6, s62, 8192
  v_mfma_f32_16x16x32_bf16 v[244:247], a[8:11], a[148:151], v[244:247]
  v_mfma_f32_16x16x32_bf16 v[244:247], a[24:27], a[172:175], v[244:247]
  buffer_load_dwordx4 v2, s[12:15], s6 offen nt lds
  v_mfma_f32_16x16x32_bf16 v[248:251], a[12:15], a[148:151], v[248:251]
  ds_read_b64_tr_b16 a[88:89], v27 offset:4096
  v_mfma_f32_16x16x32_bf16 v[248:251], a[28:31], a[172:175], v[248:251]
  ds_read_b64_tr_b16 a[90:91], v27 offset:6144
  s_waitcnt lgkmcnt(15)
  v_mfma_f32_16x16x32_bf16 v[156:159], a[32:35], a[128:131], v[156:159]
  ds_read_b128 a[148:151], v29 offset:22528
  v_mfma_f32_16x16x32_bf16 v[156:159], a[48:51], a[152:155], v[156:159]
  ds_read_b128 a[172:175], v30 offset:22528
  v_mfma_f32_16x16x32_bf16 v[160:163], a[36:39], a[128:131], v[160:163]
  ds_read_b64_tr_b16 a[92:93], v28 offset:4096
  v_mfma_f32_16x16x32_bf16 v[160:163], a[52:55], a[152:155], v[160:163]
  buffer_load_dwordx4 v3, s[12:15], s6 offen offset:1024 nt lds
  v_mfma_f32_16x16x32_bf16 v[164:167], a[40:43], a[128:131], v[164:167]
  ds_read_b64_tr_b16 a[94:95], v28 offset:6144
  v_mfma_f32_16x16x32_bf16 v[164:167], a[56:59], a[152:155], v[164:167]
  v_mfma_f32_16x16x32_bf16 v[168:171], a[44:47], a[128:131], v[168:171]
  v_mfma_f32_16x16x32_bf16 v[168:171], a[60:63], a[152:155], v[168:171]
  s_waitcnt lgkmcnt(15)
  v_mfma_f32_16x16x32_bf16 v[172:175], a[32:35], a[132:135], v[172:175]
  v_mfma_f32_16x16x32_bf16 v[172:175], a[48:51], a[156:159], v[172:175]
  v_mfma_f32_16x16x32_bf16 v[176:179], a[36:39], a[132:135], v[176:179]
  buffer_load_dwordx4 v4, s[12:15], s6 offen offset:2048 nt lds
  v_mfma_f32_16x16x32_bf16 v[176:179], a[52:55], a[156:159], v[176:179]
  v_mfma_f32_16x16x32_bf16 v[180:183], a[40:43], a[132:135], v[180:183]
  v_mfma_f32_16x16x32_bf16 v[180:183], a[56:59], a[156:159], v[180:183]
  v_mfma_f32_16x16x32_bf16 v[184:187], a[44:47], a[132:135], v[184:187]
  v_mfma_f32_16x16x32_bf16 v[184:187], a[60:63], a[156:159], v[184:187]
  v_mfma_f32_16x16x32_bf16 v[188:191], a[32:35], a[136:139], v[188:191]
  s_waitcnt lgkmcnt(14)
  v_mfma_f32_16x16x32_bf16 v[188:191], a[48:51], a[160:163], v[188:191]
  buffer_load_dwordx4 v5, s[12:15], s6 offen offset:3072 nt lds
  v_mfma_f32_16x16x32_bf16 v[192:195], a[36:39], a[136:139], v[192:195]
  v_mfma_f32_16x16x32_bf16 v[192:195], a[52:55], a[160:163], v[192:195]
  v_mfma_f32_16x16x32_bf16 v[196:199], a[40:43], a[136:139], v[196:199]
  v_mfma_f32_16x16x32_bf16 v[196:199], a[56:59], a[160:163], v[196:199]
  s_waitcnt lgkmcnt(2)
  s_barrier
  ds_read_b128 a[128:131], v29
  s_add_u32 m0, s64, 36864
  v_mfma_f32_16x16x32_bf16 v[200:203], a[44:47], a[136:139], v[200:203]
  ds_read_b128 a[152:155], v30
  v_mfma_f32_16x16x32_bf16 v[200:203], a[60:63], a[160:163], v[200:203]
  v_mfma_f32_16x16x32_bf16 v[204:207], a[32:35], a[140:143], v[204:207]
  buffer_load_dwordx4 v6, s[12:15], s6 offen nt lds
  v_mfma_f32_16x16x32_bf16 v[204:207], a[48:51], a[164:167], v[204:207]
  ds_read_b128 a[132:135], v29 offset:2048
  v_mfma_f32_16x16x32_bf16 v[208:211], a[36:39], a[140:143], v[208:211]
  ds_read_b128 a[156:159], v30 offset:2048
  v_mfma_f32_16x16x32_bf16 v[208:211], a[52:55], a[164:167], v[208:211]
  ds_read_b128 a[136:139], v29 offset:4096
  v_mfma_f32_16x16x32_bf16 v[212:215], a[40:43], a[140:143], v[212:215]
  ds_read_b128 a[160:163], v30 offset:4096
  s_lshl1_add_u32 s82, s58, s60
  v_mfma_f32_16x16x32_bf16 v[212:215], a[56:59], a[164:167], v[212:215]
  s_lshl2_add_u32 s82, s82, s56
  s_mul_i32 s82, s82, 3584
  s_mul_i32 s95, s61, 229376
  v_mfma_f32_16x16x32_bf16 v[216:219], a[44:47], a[140:143], v[216:219]
  buffer_load_dwordx4 v7, s[12:15], s6 offen offset:1024 nt lds
  s_add_u32 s82, s82, s95
  v_mfma_f32_16x16x32_bf16 v[216:219], a[60:63], a[164:167], v[216:219]
  ds_read_b128 a[140:143], v29 offset:6144
  v_min_u32 v44, 27, v1
  v_mfma_f32_16x16x32_bf16 v[220:223], a[32:35], a[144:147], v[220:223]
  ds_read_b128 a[164:167], v30 offset:6144
  v_mfma_f32_16x16x32_bf16 v[220:223], a[48:51], a[168:171], v[220:223]
  v_mfma_f32_16x16x32_bf16 v[224:227], a[36:39], a[144:147], v[224:227]
  v_mfma_f32_16x16x32_bf16 v[224:227], a[52:55], a[168:171], v[224:227]
  v_mfma_f32_16x16x32_bf16 v[228:231], a[40:43], a[144:147], v[228:231]
  v_mfma_f32_16x16x32_bf16 v[228:231], a[56:59], a[168:171], v[228:231]
  buffer_load_dwordx4 v8, s[12:15], s6 offen offset:2048 nt lds
  v_mfma_f32_16x16x32_bf16 v[232:235], a[44:47], a[144:147], v[232:235]
  v_mfma_f32_16x16x32_bf16 v[232:235], a[60:63], a[168:171], v[232:235]
  ds_read_b128 a[144:147], v29 offset:8192
  v_lshl_add_u32 v44, v44, 7, s82
  v_mfma_f32_16x16x32_bf16 v[236:239], a[32:35], a[148:151], v[236:239]
  ds_read_b128 a[168:171], v30 offset:8192
  v_mfma_f32_16x16x32_bf16 v[236:239], a[48:51], a[172:175], v[236:239]
  v_mfma_f32_16x16x32_bf16 v[240:243], a[36:39], a[148:151], v[240:243]
  v_mfma_f32_16x16x32_bf16 v[240:243], a[52:55], a[172:175], v[240:243]
  v_mfma_f32_16x16x32_bf16 v[244:247], a[40:43], a[148:151], v[244:247]
  buffer_load_dwordx4 v9, s[12:15], s6 offen offset:3072 nt lds
  v_mfma_f32_16x16x32_bf16 v[244:247], a[56:59], a[172:175], v[244:247]
  v_mfma_f32_16x16x32_bf16 v[248:251], a[44:47], a[148:151], v[248:251]
  v_mfma_f32_16x16x32_bf16 v[248:251], a[60:63], a[172:175], v[248:251]
  ds_read_b128 a[148:151], v29 offset:10240
  s_waitcnt lgkmcnt(10)
  v_mfma_f32_16x16x32_bf16 v[156:159], a[64:67], a[128:131], v[156:159]
  ds_read_b128 a[172:175], v30 offset:10240
  s_add_u32 m0, s65, 8192
  s_waitcnt lgkmcnt(10)
  v_mfma_f32_16x16x32_bf16 v[156:159], a[80:83], a[152:155], v[156:159]
  s_xor_b32 s6, s63, 0
  v_mfma_f32_16x16x32_bf16 v[160:163], a[68:71], a[128:131], v[160:163]
  v_mfma_f32_16x16x32_bf16 v[160:163], a[84:87], a[152:155], v[160:163]
  buffer_load_dwordx4 v10, s[16:19], s6 offen nt lds
  v_mfma_f32_16x16x32_bf16 v[164:167], a[72:75], a[128:131], v[164:167]
  v_mfma_f32_16x16x32_bf16 v[164:167], a[88:91], a[152:155], v[164:167]
  v_mfma_f32_16x16x32_bf16 v[168:171], a[76:79], a[128:131], v[168:171]
  s_nop 0
  v_cvt_pk_bf16_f32 v156, v156, v157
  v_cvt_pk_bf16_f32 v157, v158, v159
  v_mfma_f32_16x16x32_bf16 v[168:171], a[92:95], a[152:155], v[168:171]
  ds_write_b64 v31, v[156:157]
  s_waitcnt lgkmcnt(10)
  v_mfma_f32_16x16x32_bf16 v[172:175], a[64:67], a[132:135], v[172:175]
  v_cvt_pk_bf16_f32 v160, v160, v161
  v_cvt_pk_bf16_f32 v161, v162, v163
  s_waitcnt lgkmcnt(9)
  v_mfma_f32_16x16x32_bf16 v[172:175], a[80:83], a[156:159], v[172:175]
  ds_write_b64 v31, v[160:161] offset:512
  v_mfma_f32_16x16x32_bf16 v[176:179], a[68:71], a[132:135], v[176:179]
  v_cvt_pk_bf16_f32 v164, v164, v165
  v_cvt_pk_bf16_f32 v165, v166, v167
  v_mfma_f32_16x16x32_bf16 v[176:179], a[84:87], a[156:159], v[176:179]
  buffer_load_dwordx4 v11, s[16:19], s6 offen offset:1024 nt lds
  v_mfma_f32_16x16x32_bf16 v[180:183], a[72:75], a[132:135], v[180:183]
  ds_write_b64 v31, v[164:165] offset:1024
  v_mfma_f32_16x16x32_bf16 v[180:183], a[88:91], a[156:159], v[180:183]
  v_cvt_pk_bf16_f32 v168, v168, v169
  v_cvt_pk_bf16_f32 v169, v170, v171
  v_mfma_f32_16x16x32_bf16 v[184:187], a[76:79], a[132:135], v[184:187]
  ds_write_b64 v31, v[168:169] offset:1536
  v_mfma_f32_16x16x32_bf16 v[184:187], a[92:95], a[156:159], v[184:187]
  v_cvt_pk_bf16_f32 v172, v172, v173
  v_cvt_pk_bf16_f32 v173, v174, v175
  s_waitcnt lgkmcnt(11)
  v_mfma_f32_16x16x32_bf16 v[188:191], a[64:67], a[136:139], v[188:191]
  ds_write_b64 v31, v[172:173] offset:2048
  s_waitcnt lgkmcnt(11)
  v_mfma_f32_16x16x32_bf16 v[188:191], a[80:83], a[160:163], v[188:191]
  v_cvt_pk_bf16_f32 v176, v176, v177
  v_cvt_pk_bf16_f32 v177, v178, v179
  v_mfma_f32_16x16x32_bf16 v[192:195], a[68:71], a[136:139], v[192:195]
  ds_write_b64 v31, v[176:177] offset:2560
  v_mfma_f32_16x16x32_bf16 v[192:195], a[84:87], a[160:163], v[192:195]
  v_cvt_pk_bf16_f32 v180, v180, v181
  v_cvt_pk_bf16_f32 v181, v182, v183
  v_mfma_f32_16x16x32_bf16 v[196:199], a[72:75], a[136:139], v[196:199]
  buffer_load_dwordx4 v12, s[16:19], s6 offen offset:2048 nt lds
  v_mfma_f32_16x16x32_bf16 v[196:199], a[88:91], a[160:163], v[196:199]
  ds_write_b64 v31, v[180:181] offset:3072
  v_mfma_f32_16x16x32_bf16 v[200:203], a[76:79], a[136:139], v[200:203]
  v_cvt_pk_bf16_f32 v184, v184, v185
  v_cvt_pk_bf16_f32 v185, v186, v187
  v_mfma_f32_16x16x32_bf16 v[200:203], a[92:95], a[160:163], v[200:203]
  ds_write_b64 v31, v[184:185] offset:3584
  s_waitcnt lgkmcnt(13)
  v_mfma_f32_16x16x32_bf16 v[204:207], a[64:67], a[140:143], v[204:207]
  v_cvt_pk_bf16_f32 v188, v188, v189
  v_cvt_pk_bf16_f32 v189, v190, v191
  s_waitcnt lgkmcnt(12)
  v_mfma_f32_16x16x32_bf16 v[204:207], a[80:83], a[164:167], v[204:207]
  ds_write_b64 v31, v[188:189] offset:4096
  v_mfma_f32_16x16x32_bf16 v[208:211], a[68:71], a[140:143], v[208:211]
  v_cvt_pk_bf16_f32 v192, v192, v193
  v_cvt_pk_bf16_f32 v193, v194, v195
  v_mfma_f32_16x16x32_bf16 v[208:211], a[84:87], a[164:167], v[208:211]
  ds_write_b64 v31, v[192:193] offset:4608
  v_mfma_f32_16x16x32_bf16 v[212:215], a[72:75], a[140:143], v[212:215]
  buffer_load_dwordx4 v13, s[16:19], s6 offen offset:3072 nt lds
  v_cvt_pk_bf16_f32 v196, v196, v197
  v_mfma_f32_16x16x32_bf16 v[212:215], a[88:91], a[164:167], v[212:215]
  v_cvt_pk_bf16_f32 v197, v198, v199
  v_mfma_f32_16x16x32_bf16 v[216:219], a[76:79], a[140:143], v[216:219]
  ds_write_b64 v31, v[196:197] offset:5120
  v_mfma_f32_16x16x32_bf16 v[216:219], a[92:95], a[164:167], v[216:219]
  v_cvt_pk_bf16_f32 v200, v200, v201
  v_cvt_pk_bf16_f32 v201, v202, v203
  s_waitcnt lgkmcnt(14)
  v_mfma_f32_16x16x32_bf16 v[220:223], a[64:67], a[144:147], v[220:223]
  ds_write_b64 v31, v[200:201] offset:5632
  s_waitcnt lgkmcnt(14)
  v_mfma_f32_16x16x32_bf16 v[220:223], a[80:83], a[168:171], v[220:223]
  v_cvt_pk_bf16_f32 v204, v204, v205
  v_cvt_pk_bf16_f32 v205, v206, v207
  v_mfma_f32_16x16x32_bf16 v[224:227], a[68:71], a[144:147], v[224:227]
  ds_write_b64 v31, v[204:205] offset:6144
  v_mfma_f32_16x16x32_bf16 v[224:227], a[84:87], a[168:171], v[224:227]
  s_add_u32 m0, s65, 12288
  s_xor_b32 s6, s63, 32768
  v_cvt_pk_bf16_f32 v208, v208, v209
  v_mfma_f32_16x16x32_bf16 v[228:231], a[72:75], a[144:147], v[228:231]
  v_cvt_pk_bf16_f32 v209, v210, v211
  v_mfma_f32_16x16x32_bf16 v[228:231], a[88:91], a[168:171], v[228:231]
  buffer_load_dwordx4 v10, s[16:19], s6 offen nt lds
  v_mfma_f32_16x16x32_bf16 v[232:235], a[76:79], a[144:147], v[232:235]
  ds_write_b64 v31, v[208:209] offset:6656
  buffer_load_dword v255, v44, s[24:27], 0 offen
  v_mfma_f32_16x16x32_bf16 v[232:235], a[92:95], a[168:171], v[232:235]
  v_cvt_pk_bf16_f32 v212, v212, v213
  v_cvt_pk_bf16_f32 v213, v214, v215
  s_waitcnt lgkmcnt(15)
  v_mfma_f32_16x16x32_bf16 v[236:239], a[64:67], a[148:151], v[236:239]
  ds_write_b64 v31, v[212:213] offset:7168
  s_waitcnt lgkmcnt(15)
  v_mfma_f32_16x16x32_bf16 v[236:239], a[80:83], a[172:175], v[236:239]
  v_cvt_pk_bf16_f32 v216, v216, v217
  v_cvt_pk_bf16_f32 v217, v218, v219
  v_mfma_f32_16x16x32_bf16 v[240:243], a[68:71], a[148:151], v[240:243]
  ds_write_b64 v31, v[216:217] offset:7680
  v_mfma_f32_16x16x32_bf16 v[240:243], a[84:87], a[172:175], v[240:243]
  v_cvt_pk_bf16_f32 v220, v220, v221
  v_cvt_pk_bf16_f32 v221, v222, v223
  v_mfma_f32_16x16x32_bf16 v[244:247], a[72:75], a[148:151], v[244:247]
  ds_write_b64 v41, v[220:221]
  v_mfma_f32_16x16x32_bf16 v[244:247], a[88:91], a[172:175], v[244:247]
  v_cvt_pk_bf16_f32 v224, v224, v225
  v_cvt_pk_bf16_f32 v225, v226, v227
  v_mfma_f32_16x16x32_bf16 v[248:251], a[76:79], a[148:151], v[248:251]
  ds_write_b64 v41, v[224:225] offset:512
  v_mfma_f32_16x16x32_bf16 v[248:251], a[92:95], a[172:175], v[248:251]
  v_cvt_pk_bf16_f32 v228, v228, v229
  v_cvt_pk_bf16_f32 v229, v230, v231
  ds_write_b64 v41, v[228:229] offset:1024
  v_cvt_pk_bf16_f32 v232, v232, v233
  v_cvt_pk_bf16_f32 v233, v234, v235
  ds_write_b64 v41, v[232:233] offset:1536
  v_cvt_pk_bf16_f32 v236, v236, v237
  v_cvt_pk_bf16_f32 v237, v238, v239
  ds_write_b64 v41, v[236:237] offset:2048
  v_cvt_pk_bf16_f32 v240, v240, v241
L_it1:
  s_cbranch_execz L_it5
  v_cvt_pk_bf16_f32 v241, v242, v243
  ds_write_b64 v41, v[240:241] offset:2560
  v_cvt_pk_bf16_f32 v244, v244, v245
  v_cvt_pk_bf16_f32 v245, v246, v247
  ds_write_b64 v41, v[244:245] offset:3072
  v_cvt_pk_bf16_f32 v248, v248, v249
  v_cvt_pk_bf16_f32 v249, v250, v251
  ds_write_b64 v41, v[248:249] offset:3584
L_attn:
  buffer_load_dwordx4 v11, s[16:19], s6 offen offset:1024 nt lds
  s_waitcnt vmcnt(15)
  ds_read_b128 a[192:195], v21
  ds_read_b128 a[196:199], v22
  ds_read_b128 a[200:203], v23
  ds_read_b128 a[204:207], v24
  ds_read_b128 a[208:211], v21 offset:256
  ds_read_b128 a[212:215], v22 offset:256
  ds_read_b128 a[216:219], v23 offset:256
  ds_read_b128 a[220:223], v24 offset:256
  buffer_load_dwordx4 v12, s[16:19], s6 offen offset:2048 nt lds
  s_waitcnt lgkmcnt(8)
  s_barrier
  ds_read_b128 a[0:3], v32
  ds_read_b128 a[24:27], v32 offset:1024
  ds_read_b128 a[48:51], v32 offset:16384
  ds_read_b128 a[72:75], v32 offset:17408
  ds_read_b128 a[96:99], v32 offset:32768
  ds_read_b128 a[120:123], v32 offset:33792
  ds_read_b128 a[144:147], v32 offset:49152
  ds_read_b128 a[168:171], v32 offset:50176
  buffer_load_dwordx4 v13, s[16:19], s6 offen offset:3072 nt lds
  s_waitcnt lgkmcnt(7)
  v_mfma_f32_16x16x32_bf16 v[156:159], a[192:195], a[0:3], 0
  ds_read_b128 a[4:7], v32 offset:2048
  s_waitcnt lgkmcnt(7)
  v_mfma_f32_16x16x32_bf16 v[156:159], a[196:199], a[24:27], v[156:159]
  ds_read_b128 a[28:31], v32 offset:3072
  s_waitcnt lgkmcnt(7)
  v_mfma_f32_16x16x32_bf16 v[156:159], a[200:203], a[48:51], v[156:159]
  ds_read_b128 a[52:55], v32 offset:18432
  s_waitcnt lgkmcnt(7)
  v_mfma_f32_16x16x32_bf16 v[156:159], a[204:207], a[72:75], v[156:159]
  ds_read_b128 a[76:79], v32 offset:19456
  s_waitcnt lgkmcnt(7)
  v_mfma_f32_16x16x32_bf16 v[156:159], a[208:211], a[96:99], v[156:159]
  ds_read_b128 a[100:103], v32 offset:34816
  s_add_u32 m0, s64, 0
  s_waitcnt lgkmcnt(7)
  v_mfma_f32_16x16x32_bf16 v[156:159], a[212:215], a[120:123], v[156:159]
  ds_read_b128 a[124:127], v32 offset:35840
  s_xor_b32 s6, s62, 65536
  s_waitcnt lgkmcnt(7)
  v_mfma_f32_16x16x32_bf16 v[156:159], a[216:219], a[144:147], v[156:159]
  ds_read_b128 a[148:151], v32 offset:51200
  s_waitcnt lgkmcnt(7)
  v_mfma_f32_16x16x32_bf16 v[156:159], a[220:223], a[168:171], v[156:159]
  buffer_load_dwordx4 v2, s[12:15], s6 offen nt lds
  s_waitcnt lgkmcnt(6)
  v_mfma_f32_16x16x32_bf16 v[160:163], a[192:195], a[4:7], 0
  ds_read_b128 a[172:175], v32 offset:52224
  s_waitcnt lgkmcnt(6)
  v_mfma_f32_16x16x32_bf16 v[160:163], a[196:199], a[28:31], v[160:163]
  ds_read_b128 a[8:11], v32 offset:4096
  s_waitcnt lgkmcnt(6)
  v_mfma_f32_16x16x32_bf16 v[160:163], a[200:203], a[52:55], v[160:163]
  ds_read_b128 a[32:35], v32 offset:5120
  s_waitcnt lgkmcnt(6)
  v_mfma_f32_16x16x32_bf16 v[160:163], a[204:207], a[76:79], v[160:163]
  ds_read_b128 a[56:59], v32 offset:20480
  s_waitcnt lgkmcnt(6)
  v_mfma_f32_16x16x32_bf16 v[160:163], a[208:211], a[100:103], v[160:163]
  ds_read_b128 a[80:83], v32 offset:21504
  v_fma_f32 v156, v156, s94, v54
  s_waitcnt lgkmcnt(6)
  v_mfma_f32_16x16x32_bf16 v[160:163], a[212:215], a[124:127], v[160:163]
  buffer_load_dwordx4 v3, s[12:15], s6 offen offset:1024 nt lds
  v_fma_f32 v157, v157, s94, v54
  s_waitcnt lgkmcnt(5)
  v_mfma_f32_16x16x32_bf16 v[160:163], a[216:219], a[148:151], v[160:163]
  ds_read_b128 a[104:107], v32 offset:36864
  v_fma_f32 v158, v158, s94, v54
  s_waitcnt lgkmcnt(5)
  v_mfma_f32_16x16x32_bf16 v[160:163], a[220:223], a[172:175], v[160:163]
  ds_read_b128 a[128:131], v32 offset:37888
  v_fma_f32 v159, v159, s94, v54
  s_waitcnt lgkmcnt(5)
  v_mfma_f32_16x16x32_bf16 v[164:167], a[192:195], a[8:11], 0
  ds_read_b128 a[152:155], v32 offset:53248
  s_waitcnt lgkmcnt(5)
  v_mfma_f32_16x16x32_bf16 v[164:167], a[196:199], a[32:35], v[164:167]
  ds_read_b128 a[176:179], v32 offset:54272
  s_waitcnt lgkmcnt(5)
  v_mfma_f32_16x16x32_bf16 v[164:167], a[200:203], a[56:59], v[164:167]
  ds_read_b128 a[12:15], v32 offset:6144
  s_waitcnt lgkmcnt(5)
  v_mfma_f32_16x16x32_bf16 v[164:167], a[204:207], a[80:83], v[164:167]
  ds_read_b128 a[36:39], v32 offset:7168
  s_waitcnt lgkmcnt(5)
  v_mfma_f32_16x16x32_bf16 v[164:167], a[208:211], a[104:107], v[164:167]
  buffer_load_dwordx4 v4, s[12:15], s6 offen offset:2048 nt lds
  v_fma_f32 v160, v160, s94, v55
  ds_read_b128 a[60:63], v32 offset:22528
  s_waitcnt lgkmcnt(5)
  v_mfma_f32_16x16x32_bf16 v[164:167], a[212:215], a[128:131], v[164:167]
  ds_read_b128 a[84:87], v32 offset:23552
  v_fma_f32 v161, v161, s94, v55
  s_waitcnt lgkmcnt(5)
  v_mfma_f32_16x16x32_bf16 v[164:167], a[216:219], a[152:155], v[164:167]
  ds_read_b128 a[108:111], v32 offset:38912
  v_fma_f32 v162, v162, s94, v55
  s_waitcnt lgkmcnt(5)
  v_mfma_f32_16x16x32_bf16 v[164:167], a[220:223], a[176:179], v[164:167]
  ds_read_b128 a[132:135], v32 offset:39936
  v_fma_f32 v163, v163, s94, v55
  s_waitcnt lgkmcnt(5)
  v_mfma_f32_16x16x32_bf16 v[168:171], a[192:195], a[12:15], 0
  ds_read_b128 a[156:159], v32 offset:55296
  s_waitcnt lgkmcnt(5)
  v_mfma_f32_16x16x32_bf16 v[168:171], a[196:199], a[36:39], v[168:171]
  ds_read_b128 a[180:183], v32 offset:56320
  s_waitcnt lgkmcnt(5)
  v_mfma_f32_16x16x32_bf16 v[168:171], a[200:203], a[60:63], v[168:171]
  buffer_load_dwordx4 v5, s[12:15], s6 offen offset:3072 nt lds
  ds_read_b128 a[16:19], v34 offset:16384
  s_waitcnt lgkmcnt(5)
  v_mfma_f32_16x16x32_bf16 v[168:171], a[204:207], a[84:87], v[168:171]
  ds_read_b128 a[40:43], v34 offset:17408
  s_waitcnt lgkmcnt(5)
  v_mfma_f32_16x16x32_bf16 v[168:171], a[208:211], a[108:111], v[168:171]
  ds_read_b128 a[64:67], v34 offset:20480
  v_fma_f32 v164, v164, s94, v56
  s_waitcnt lgkmcnt(5)
  v_mfma_f32_16x16x32_bf16 v[168:171], a[212:215], a[132:135], v[168:171]
  ds_read_b128 a[88:91], v34 offset:21504
  v_fma_f32 v165, v165, s94, v56
  s_waitcnt lgkmcnt(5)
  v_mfma_f32_16x16x32_bf16 v[168:171], a[216:219], a[156:159], v[168:171]
  ds_read_b128 a[112:115], v34 offset:24576
  s_add_u32 m0, s64, 4096
  s_waitcnt lgkmcnt(5)
  v_mfma_f32_16x16x32_bf16 v[168:171], a[220:223], a[180:183], v[168:171]
  ds_read_b128 a[136:139], v34 offset:25600
  v_fma_f32 v166, v166, s94, v56
  s_waitcnt lgkmcnt(5)
  v_mfma_f32_16x16x32_bf16 v[172:175], a[192:195], a[16:19], 0
  ds_read_b128 a[160:163], v34 offset:28672
  v_fma_f32 v167, v167, s94, v56
  s_waitcnt lgkmcnt(5)
  v_mfma_f32_16x16x32_bf16 v[172:175], a[196:199], a[40:43], v[172:175]
  buffer_load_dwordx4 v6, s[12:15], s6 offen nt lds
  ds_read_b128 a[184:187], v34 offset:29696
  s_waitcnt lgkmcnt(5)
  v_mfma_f32_16x16x32_bf16 v[172:175], a[200:203], a[64:67], v[172:175]
  ds_read_b128 a[20:23], v34 offset:18432
  s_waitcnt lgkmcnt(5)
  v_mfma_f32_16x16x32_bf16 v[172:175], a[204:207], a[88:91], v[172:175]
  ds_read_b128 a[44:47], v34 offset:19456
  s_waitcnt lgkmcnt(5)
  v_mfma_f32_16x16x32_bf16 v[172:175], a[208:211], a[112:115], v[172:175]
  ds_read_b128 a[68:71], v34 offset:22528
  v_fma_f32 v168, v168, s94, v57
  s_waitcnt lgkmcnt(5)
  v_mfma_f32_16x16x32_bf16 v[172:175], a[212:215], a[136:139], v[172:175]
  ds_read_b128 a[92:95], v34 offset:23552
  v_fma_f32 v169, v169, s94, v57
  s_waitcnt lgkmcnt(5)
  v_mfma_f32_16x16x32_bf16 v[172:175], a[216:219], a[160:163], v[172:175]
  ds_read_b128 a[116:119], v34 offset:26624
  v_fma_f32 v170, v170, s94, v57
  s_waitcnt lgkmcnt(5)
  v_mfma_f32_16x16x32_bf16 v[172:175], a[220:223], a[184:187], v[172:175]
  buffer_load_dwordx4 v7, s[12:15], s6 offen offset:1024 nt lds
  v_fma_f32 v171, v171, s94, v57
  ds_read_b128 a[140:143], v34 offset:27648
  s_waitcnt lgkmcnt(5)
  v_mfma_f32_16x16x32_bf16 v[176:179], a[192:195], a[20:23], 0
  ds_read_b128 a[164:167], v34 offset:30720
  s_waitcnt lgkmcnt(5)
  v_mfma_f32_16x16x32_bf16 v[176:179], a[196:199], a[44:47], v[176:179]
  s_waitcnt vmcnt(15)
  ds_read_b128 a[188:191], v34 offset:31744
  s_waitcnt lgkmcnt(5)
  v_mfma_f32_16x16x32_bf16 v[176:179], a[200:203], a[68:71], v[176:179]
  ds_read_b128 a[192:195], v21 offset:32768
  s_waitcnt lgkmcnt(5)
  v_mfma_f32_16x16x32_bf16 v[176:179], a[204:207], a[92:95], v[176:179]
  ds_read_b128 a[196:199], v22 offset:32768
  s_waitcnt lgkmcnt(5)
  v_mfma_f32_16x16x32_bf16 v[176:179], a[208:211], a[116:119], v[176:179]
  ds_read_b128 a[200:203], v23 offset:32768
  v_fma_f32 v172, v172, s94, v58
  s_waitcnt lgkmcnt(5)
  v_mfma_f32_16x16x32_bf16 v[176:179], a[212:215], a[140:143], v[176:179]
  ds_read_b128 a[204:207], v24 offset:32768
  v_fma_f32 v173, v173, s94, v58
  s_waitcnt lgkmcnt(5)
  v_mfma_f32_16x16x32_bf16 v[176:179], a[216:219], a[164:167], v[176:179]
  buffer_load_dwordx4 v8, s[12:15], s6 offen offset:2048 nt lds
  v_fma_f32 v174, v174, s94, v58
  ds_read_b128 a[208:211], v21 offset:33024
  s_waitcnt lgkmcnt(5)
  v_mfma_f32_16x16x32_bf16 v[176:179], a[220:223], a[188:191], v[176:179]
  ds_read_b128 a[212:215], v22 offset:33024
  v_fma_f32 v175, v175, s94, v58
  s_waitcnt lgkmcnt(5)
  v_mfma_f32_16x16x32_bf16 v[60:63], a[192:195], a[0:3], 0
  s_barrier
  ds_read_b128 a[216:219], v23 offset:33024
  s_waitcnt lgkmcnt(5)
  v_mfma_f32_16x16x32_bf16 v[60:63], a[196:199], a[24:27], v[60:63]
  ds_read_b128 a[220:223], v24 offset:33024
  s_waitcnt lgkmcnt(5)
  v_mfma_f32_16x16x32_bf16 v[60:63], a[200:203], a[48:51], v[60:63]
  v_exp_f32 v156, v156
  s_waitcnt lgkmcnt(4)
  v_mfma_f32_16x16x32_bf16 v[60:63], a[204:207], a[72:75], v[60:63]
  v_exp_f32 v157, v157
  s_waitcnt lgkmcnt(3)
  v_mfma_f32_16x16x32_bf16 v[60:63], a[208:211], a[96:99], v[60:63]
  buffer_load_dwordx4 v9, s[12:15], s6 offen offset:3072 nt lds
  v_fma_f32 v176, v176, s94, v59
  s_waitcnt lgkmcnt(2)
  v_mfma_f32_16x16x32_bf16 v[60:63], a[212:215], a[120:123], v[60:63]
  v_exp_f32 v158, v158
  s_waitcnt lgkmcnt(1)
  v_mfma_f32_16x16x32_bf16 v[60:63], a[216:219], a[144:147], v[60:63]
  v_exp_f32 v159, v159
  s_waitcnt lgkmcnt(0)
  v_mfma_f32_16x16x32_bf16 v[60:63], a[220:223], a[168:171], v[60:63]
  v_add_f32 v48, v156, v157
  v_cvt_pk_bf16_f32 v156, v156, v157
  v_mfma_f32_16x16x32_bf16 v[64:67], a[192:195], a[4:7], 0
  s_add_u32 m0, s65, 0
  s_xor_b32 s6, s63, 8192
  v_add_f32 v48, v48, v158
  v_mfma_f32_16x16x32_bf16 v[64:67], a[196:199], a[28:31], v[64:67]
  v_exp_f32 v160, v160
  v_mfma_f32_16x16x32_bf16 v[64:67], a[200:203], a[52:55], v[64:67]
  v_exp_f32 v161, v161
  v_add_f32 v48, v48, v159
  v_cvt_pk_bf16_f32 v157, v158, v159
  ds_write_b64 v33, v[156:157]
  v_mfma_f32_16x16x32_bf16 v[64:67], a[204:207], a[76:79], v[64:67]
  buffer_load_dwordx4 v10, s[16:19], s6 offen nt lds
  v_fma_f32 v177, v177, s94, v59
  v_mfma_f32_16x16x32_bf16 v[64:67], a[208:211], a[100:103], v[64:67]
  v_exp_f32 v162, v162
  v_mfma_f32_16x16x32_bf16 v[64:67], a[212:215], a[124:127], v[64:67]
  v_exp_f32 v163, v163
  v_mfma_f32_16x16x32_bf16 v[64:67], a[216:219], a[148:151], v[64:67]
  v_add_f32 v49, v160, v161
  v_cvt_pk_bf16_f32 v160, v160, v161
  v_mfma_f32_16x16x32_bf16 v[64:67], a[220:223], a[172:175], v[64:67]
  v_exp_f32 v164, v164
  v_add_f32 v49, v49, v162
  v_add_f32 v49, v49, v163
  v_cvt_pk_bf16_f32 v161, v162, v163
  ds_write_b64 v33, v[160:161] offset:1024
  v_mfma_f32_16x16x32_bf16 v[68:71], a[192:195], a[8:11], 0
  v_exp_f32 v165, v165
  v_mfma_f32_16x16x32_bf16 v[68:71], a[196:199], a[32:35], v[68:71]
  buffer_load_dwordx4 v11, s[16:19], s6 offen offset:1024 nt lds
  v_fma_f32 v178, v178, s94, v59
  v_mfma_f32_16x16x32_bf16 v[68:71], a[200:203], a[56:59], v[68:71]
  v_exp_f32 v166, v166
  v_mfma_f32_16x16x32_bf16 v[68:71], a[204:207], a[80:83], v[68:71]
  v_exp_f32 v167, v167
  v_mfma_f32_16x16x32_bf16 v[68:71], a[208:211], a[104:107], v[68:71]
  v_add_f32 v50, v164, v165
  v_cvt_pk_bf16_f32 v164, v164, v165
  v_add_f32 v50, v50, v166
  v_add_f32 v50, v50, v167
  v_cvt_pk_bf16_f32 v165, v166, v167
  ds_write_b64 v33, v[164:165] offset:2048
  v_mfma_f32_16x16x32_bf16 v[68:71], a[212:215], a[128:131], v[68:71]
  v_exp_f32 v168, v168
  v_mfma_f32_16x16x32_bf16 v[68:71], a[216:219], a[152:155], v[68:71]
  v_exp_f32 v169, v169
  v_mfma_f32_16x16x32_bf16 v[68:71], a[220:223], a[176:179], v[68:71]
  buffer_load_dwordx4 v12, s[16:19], s6 offen offset:2048 nt lds
  v_fma_f32 v179, v179, s94, v59
  v_mfma_f32_16x16x32_bf16 v[72:75], a[192:195], a[12:15], 0
  v_exp_f32 v170, v170
  v_mfma_f32_16x16x32_bf16 v[72:75], a[196:199], a[36:39], v[72:75]
  v_exp_f32 v171, v171
  v_add_f32 v51, v168, v169
  v_cvt_pk_bf16_f32 v168, v168, v169
  v_add_f32 v51, v51, v170
  v_add_f32 v51, v51, v171
  v_cvt_pk_bf16_f32 v169, v170, v171
  ds_write_b64 v33, v[168:169] offset:3072
  v_mfma_f32_16x16x32_bf16 v[72:75], a[200:203], a[60:63], v[72:75]
  v_exp_f32 v172, v172
  v_mfma_f32_16x16x32_bf16 v[72:75], a[204:207], a[84:87], v[72:75]
  v_exp_f32 v173, v173
  v_mfma_f32_16x16x32_bf16 v[72:75], a[208:211], a[108:111], v[72:75]
  s_waitcnt vmcnt(16)
  v_exp_f32 v174, v174
  v_mfma_f32_16x16x32_bf16 v[72:75], a[212:215], a[132:135], v[72:75]
  buffer_load_dwordx4 v13, s[16:19], s6 offen offset:3072 nt lds
  v_mfma_f32_16x16x32_bf16 v[72:75], a[216:219], a[156:159], v[72:75]
  v_exp_f32 v175, v175
  v_add_f32 v52, v172, v173
  v_cvt_pk_bf16_f32 v172, v172, v173
  v_add_f32 v52, v52, v174
  v_add_f32 v52, v52, v175
  v_cvt_pk_bf16_f32 v173, v174, v175
  ds_write_b64 v33, v[172:173] offset:4096
  v_mfma_f32_16x16x32_bf16 v[72:75], a[220:223], a[180:183], v[72:75]
  v_exp_f32 v176, v176
  v_mfma_f32_16x16x32_bf16 v[76:79], a[192:195], a[16:19], 0
  s_add_u32 m0, s65, 4096
  s_xor_b32 s6, s63, 40960
  v_mfma_f32_16x16x32_bf16 v[76:79], a[196:199], a[40:43], v[76:79]
  v_exp_f32 v177, v177
  v_mfma_f32_16x16x32_bf16 v[76:79], a[200:203], a[64:67], v[76:79]
  v_exp_f32 v178, v178
  v_mfma_f32_16x16x32_bf16 v[76:79], a[204:207], a[88:91], v[76:79]
  buffer_load_dwordx4 v10, s[16:19], s6 offen nt lds
  v_exp_f32 v179, v179
  v_add_f32 v53, v176, v177
  v_cvt_pk_bf16_f32 v176, v176, v177
  v_add_f32 v53, v53, v178
  v_add_f32 v53, v53, v179
  v_cvt_pk_bf16_f32 v177, v178, v179
  ds_write_b64 v33, v[176:177] offset:5120
  v_mfma_f32_16x16x32_bf16 v[76:79], a[208:211], a[112:115], v[76:79]
  ds_read_b64_tr_b16 a[224:225], v25 offset:8192
  ds_read_b64_tr_b16 a[226:227], v25 offset:10240
  v_mfma_f32_16x16x32_bf16 v[76:79], a[212:215], a[136:139], v[76:79]
  s_waitcnt lgkmcnt(2)
  s_barrier
  s_waitcnt vmcnt(13)
  ds_read_b128 v[108:111], v34
  v_mfma_f32_16x16x32_bf16 v[76:79], a[216:219], a[160:163], v[76:79]
  ds_read_b64_tr_b16 a[240:241], v25 offset:12288
  v_mfma_f32_16x16x32_bf16 v[76:79], a[220:223], a[184:187], v[76:79]
  ds_read_b128 v[132:135], v34 offset:6144
  v_fma_f32 v60, v60, s94, v54
  v_mfma_f32_16x16x32_bf16 v[80:83], a[192:195], a[20:23], 0
  ds_read_b64_tr_b16 a[242:243], v25 offset:14336
  v_fma_f32 v61, v61, s94, v54
  v_mfma_f32_16x16x32_bf16 v[80:83], a[196:199], a[44:47], v[80:83]
  buffer_load_dwordx4 v11, s[16:19], s6 offen offset:1024 nt lds
  v_fma_f32 v62, v62, s94, v54
  v_mfma_f32_16x16x32_bf16 v[80:83], a[200:203], a[68:71], v[80:83]
  ds_read_b128 v[112:115], v34 offset:1024
  v_fma_f32 v63, v63, s94, v54
  v_mfma_f32_16x16x32_bf16 v[80:83], a[204:207], a[92:95], v[80:83]
  ds_read_b128 v[136:139], v34 offset:7168
  v_fma_f32 v64, v64, s94, v55
  v_mfma_f32_16x16x32_bf16 v[80:83], a[208:211], a[116:119], v[80:83]
  ds_read_b128 v[116:119], v34 offset:2048
  v_fma_f32 v65, v65, s94, v55
  ds_read_b128 v[140:143], v34 offset:8192
  v_mfma_f32_16x16x32_bf16 v[80:83], a[212:215], a[140:143], v[80:83]
  ds_read_b128 v[120:123], v34 offset:3072
  v_fma_f32 v66, v66, s94, v55
  v_mfma_f32_16x16x32_bf16 v[80:83], a[216:219], a[164:167], v[80:83]
  ds_read_b64_tr_b16 a[228:229], v26 offset:8192
  v_fma_f32 v67, v67, s94, v55
  v_mfma_f32_16x16x32_bf16 v[80:83], a[220:223], a[188:191], v[80:83]
  buffer_load_dwordx4 v12, s[16:19], s6 offen offset:2048 nt lds
  v_fma_f32 v68, v68, s94, v56
  s_waitcnt lgkmcnt(9)
  v_mfma_f32_16x16x32_bf16 v[156:159], a[224:227], v[108:111], 0
  ds_read_b128 v[144:147], v34 offset:9216
  v_fma_f32 v69, v69, s94, v56
  ds_read_b64_tr_b16 a[230:231], v26 offset:10240
  s_waitcnt lgkmcnt(8)
  v_mfma_f32_16x16x32_bf16 v[156:159], a[240:243], v[132:135], v[156:159]
  ds_read_b128 v[124:127], v34 offset:4096
  v_fma_f32 v70, v70, s94, v56
  s_waitcnt lgkmcnt(8)
  v_mfma_f32_16x16x32_bf16 v[172:175], a[224:227], v[112:115], 0
  ds_read_b128 v[148:151], v34 offset:10240
  v_fma_f32 v71, v71, s94, v56
  ds_read_b128 v[128:131], v34 offset:5120
  ds_read_b128 v[152:155], v34 offset:11264
  s_waitcnt lgkmcnt(10)
  v_mfma_f32_16x16x32_bf16 v[172:175], a[240:243], v[136:139], v[172:175]
  ds_read_b64_tr_b16 a[244:245], v26 offset:12288
  v_fma_f32 v72, v72, s94, v57
  s_waitcnt lgkmcnt(10)
  v_mfma_f32_16x16x32_bf16 v[188:191], a[224:227], v[116:119], 0
  ds_read_b64_tr_b16 a[246:247], v26 offset:14336
  v_fma_f32 v73, v73, s94, v57
  s_waitcnt lgkmcnt(10)
  v_mfma_f32_16x16x32_bf16 v[188:191], a[240:243], v[140:143], v[188:191]
  buffer_load_dwordx4 v13, s[16:19], s6 offen offset:3072 nt lds
  v_fma_f32 v74, v74, s94, v57
  s_waitcnt lgkmcnt(9)
  v_mfma_f32_16x16x32_bf16 v[204:207], a[224:227], v[120:123], 0
  ds_read_b64_tr_b16 a[232:233], v27 offset:8192
  v_fma_f32 v75, v75, s94, v57
  s_waitcnt lgkmcnt(8)
  v_mfma_f32_16x16x32_bf16 v[204:207], a[240:243], v[144:147], v[204:207]
  ds_read_b64_tr_b16 a[234:235], v27 offset:10240
  v_fma_f32 v76, v76, s94, v58
  s_waitcnt lgkmcnt(7)
  v_mfma_f32_16x16x32_bf16 v[220:223], a[224:227], v[124:127], 0
  v_exp_f32 v60, v60
  s_waitcnt lgkmcnt(6)
  v_mfma_f32_16x16x32_bf16 v[220:223], a[240:243], v[148:151], v[220:223]
  s_add_u32 m0, s64, 32768
  s_xor_b32 s6, s62, 73728
  v_fma_f32 v77, v77, s94, v58
  s_waitcnt lgkmcnt(5)
  v_mfma_f32_16x16x32_bf16 v[236:239], a[224:227], v[128:131], 0
  ds_read_b64_tr_b16 a[248:249], v27 offset:12288
  v_fma_f32 v78, v78, s94, v58
  s_waitcnt lgkmcnt(5)
  v_mfma_f32_16x16x32_bf16 v[236:239], a[240:243], v[152:155], v[236:239]
  v_exp_f32 v61, v61
  v_mfma_f32_16x16x32_bf16 v[160:163], a[228:231], v[108:111], 0
  buffer_load_dwordx4 v2, s[12:15], s6 offen nt lds
  v_fma_f32 v79, v79, s94, v58
  s_waitcnt lgkmcnt(3)
  v_mfma_f32_16x16x32_bf16 v[160:163], a[244:247], v[132:135], v[160:163]
  ds_read_b64_tr_b16 a[250:251], v27 offset:14336
  v_fma_f32 v80, v80, s94, v59
  v_mfma_f32_16x16x32_bf16 v[176:179], a[228:231], v[112:115], 0
  v_exp_f32 v62, v62
  v_mfma_f32_16x16x32_bf16 v[176:179], a[244:247], v[136:139], v[176:179]
  v_exp_f32 v63, v63
  v_mfma_f32_16x16x32_bf16 v[192:195], a[228:231], v[116:119], 0
  ds_read_b64_tr_b16 a[236:237], v28 offset:8192
  v_add_f32 v48, v48, v60
  v_mfma_f32_16x16x32_bf16 v[192:195], a[244:247], v[140:143], v[192:195]
  v_add_f32 v48, v48, v61
  v_cvt_pk_bf16_f32 v60, v60, v61
  v_mfma_f32_16x16x32_bf16 v[208:211], a[228:231], v[120:123], 0
  buffer_load_dwordx4 v3, s[12:15], s6 offen offset:1024 nt lds
  v_add_f32 v48, v48, v62
  v_mfma_f32_16x16x32_bf16 v[208:211], a[244:247], v[144:147], v[208:211]
  ds_read_b64_tr_b16 a[238:239], v28 offset:10240
  v_add_f32 v48, v48, v63
  v_mfma_f32_16x16x32_bf16 v[224:227], a[228:231], v[124:127], 0
  v_exp_f32 v64, v64
  v_mfma_f32_16x16x32_bf16 v[224:227], a[244:247], v[148:151], v[224:227]
  v_exp_f32 v65, v65
  v_mfma_f32_16x16x32_bf16 v[240:243], a[228:231], v[128:131], 0
  ds_read_b64_tr_b16 a[252:253], v28 offset:12288
  v_cvt_pk_bf16_f32 v61, v62, v63
  v_mfma_f32_16x16x32_bf16 v[240:243], a[244:247], v[152:155], v[240:243]
  ds_write_b64 v33, v[60:61] offset:12288
  s_waitcnt lgkmcnt(6)
  v_mfma_f32_16x16x32_bf16 v[164:167], a[232:235], v[108:111], 0
  buffer_load_dwordx4 v4, s[12:15], s6 offen offset:2048 nt lds
  v_fma_f32 v81, v81, s94, v59
  s_waitcnt lgkmcnt(4)
  v_mfma_f32_16x16x32_bf16 v[164:167], a[248:251], v[132:135], v[164:167]
  ds_read_b64_tr_b16 a[254:255], v28 offset:14336
  v_fma_f32 v82, v82, s94, v59
  v_mfma_f32_16x16x32_bf16 v[180:183], a[232:235], v[112:115], 0
  v_exp_f32 v66, v66
  v_mfma_f32_16x16x32_bf16 v[180:183], a[248:251], v[136:139], v[180:183]
  v_exp_f32 v67, v67
  v_mfma_f32_16x16x32_bf16 v[196:199], a[232:235], v[116:119], 0
  v_add_f32 v49, v49, v64
  v_add_f32 v49, v49, v65
  v_mfma_f32_16x16x32_bf16 v[196:199], a[248:251], v[140:143], v[196:199]
  s_waitcnt vmcnt(11)
  ds_read_b128 a[192:195], v21
  v_cvt_pk_bf16_f32 v64, v64, v65
  v_mfma_f32_16x16x32_bf16 v[212:215], a[232:235], v[120:123], 0
  buffer_load_dwordx4 v5, s[12:15], s6 offen offset:3072 nt lds
  v_add_f32 v49, v49, v66
  v_mfma_f32_16x16x32_bf16 v[212:215], a[248:251], v[144:147], v[212:215]
  ds_read_b128 a[196:199], v22
  v_add_f32 v49, v49, v67
  v_mfma_f32_16x16x32_bf16 v[228:231], a[232:235], v[124:127], 0
  v_exp_f32 v68, v68
  v_mfma_f32_16x16x32_bf16 v[228:231], a[248:251], v[148:151], v[228:231]
  ds_read_b128 a[200:203], v23
  s_add_u32 m0, s64, 36864
  v_mfma_f32_16x16x32_bf16 v[244:247], a[232:235], v[128:131], 0
  v_exp_f32 v69, v69
  v_mfma_f32_16x16x32_bf16 v[244:247], a[248:251], v[152:155], v[244:247]
  ds_read_b128 a[204:207], v24
  v_cvt_pk_bf16_f32 v65, v66, v67
  s_waitcnt lgkmcnt(7)
  v_mfma_f32_16x16x32_bf16 v[168:171], a[236:239], v[108:111], 0
  buffer_load_dwordx4 v6, s[12:15], s6 offen nt lds
  v_fma_f32 v83, v83, s94, v59
  s_waitcnt lgkmcnt(4)
  v_mfma_f32_16x16x32_bf16 v[168:171], a[252:255], v[132:135], v[168:171]
  ds_write_b64 v33, v[64:65] offset:13312
  v_mfma_f32_16x16x32_bf16 v[184:187], a[236:239], v[112:115], 0
  ds_read_b128 a[208:211], v21 offset:256
  v_mfma_f32_16x16x32_bf16 v[184:187], a[252:255], v[136:139], v[184:187]
  v_exp_f32 v70, v70
  v_mfma_f32_16x16x32_bf16 v[200:203], a[236:239], v[116:119], 0
  v_exp_f32 v71, v71
  v_mfma_f32_16x16x32_bf16 v[200:203], a[252:255], v[140:143], v[200:203]
  ds_read_b128 a[212:215], v22 offset:256
  v_add_f32 v50, v50, v68
  v_mfma_f32_16x16x32_bf16 v[216:219], a[236:239], v[120:123], 0
  buffer_load_dwordx4 v7, s[12:15], s6 offen offset:1024 nt lds
  v_add_f32 v50, v50, v69
  v_mfma_f32_16x16x32_bf16 v[216:219], a[252:255], v[144:147], v[216:219]
  ds_read_b128 a[216:219], v23 offset:256
  v_cvt_pk_bf16_f32 v68, v68, v69
  v_mfma_f32_16x16x32_bf16 v[232:235], a[236:239], v[124:127], 0
  ds_read_b128 a[220:223], v24 offset:256
  v_add_f32 v50, v50, v70
  v_mfma_f32_16x16x32_bf16 v[232:235], a[252:255], v[148:151], v[232:235]
  v_exp_f32 v72, v72
  v_mfma_f32_16x16x32_bf16 v[248:251], a[236:239], v[128:131], 0
  v_add_f32 v50, v50, v71
  v_cvt_pk_bf16_f32 v69, v70, v71
  ds_write_b64 v33, v[68:69] offset:14336
  v_mfma_f32_16x16x32_bf16 v[248:251], a[252:255], v[152:155], v[248:251]
  v_exp_f32 v73, v73
  s_waitcnt lgkmcnt(9)
  v_mfma_f32_16x16x32_bf16 v[60:63], a[192:195], a[0:3], 0
  buffer_load_dwordx4 v8, s[12:15], s6 offen offset:2048 nt lds
  s_waitcnt lgkmcnt(8)
  v_mfma_f32_16x16x32_bf16 v[60:63], a[196:199], a[24:27], v[60:63]
  v_exp_f32 v74, v74
  s_waitcnt lgkmcnt(7)
  v_mfma_f32_16x16x32_bf16 v[60:63], a[200:203], a[48:51], v[60:63]
  v_exp_f32 v75, v75
  s_waitcnt lgkmcnt(6)
  v_mfma_f32_16x16x32_bf16 v[60:63], a[204:207], a[72:75], v[60:63]
  v_add_f32 v51, v51, v72
  v_add_f32 v51, v51, v73
  s_waitcnt lgkmcnt(4)
  v_mfma_f32_16x16x32_bf16 v[60:63], a[208:211], a[96:99], v[60:63]
  v_cvt_pk_bf16_f32 v72, v72, v73
  v_add_f32 v51, v51, v74
  v_add_f32 v51, v51, v75
  v_cvt_pk_bf16_f32 v73, v74, v75
  ds_write_b64 v33, v[72:73] offset:15360
  s_waitcnt lgkmcnt(4)
  v_mfma_f32_16x16x32_bf16 v[60:63], a[212:215], a[120:123], v[60:63]
  v_exp_f32 v76, v76
  s_waitcnt lgkmcnt(3)
  v_mfma_f32_16x16x32_bf16 v[60:63], a[216:219], a[144:147], v[60:63]
  buffer_load_dwordx4 v9, s[12:15], s6 offen offset:3072 nt lds
  s_waitcnt lgkmcnt(2)
  v_mfma_f32_16x16x32_bf16 v[60:63], a[220:223], a[168:171], v[60:63]
  v_exp_f32 v77, v77
  v_mfma_f32_16x16x32_bf16 v[64:67], a[192:195], a[4:7], 0
  v_exp_f32 v78, v78
  v_mfma_f32_16x16x32_bf16 v[64:67], a[196:199], a[28:31], v[64:67]
  v_exp_f32 v79, v79
  v_mfma_f32_16x16x32_bf16 v[64:67], a[200:203], a[52:55], v[64:67]
  s_add_u32 m0, s65, 8192
  s_xor_b32 s6, s63, 65536
  v_add_f32 v52, v52, v76
  v_add_f32 v52, v52, v77
  v_cvt_pk_bf16_f32 v76, v76, v77
  v_add_f32 v52, v52, v78
  v_add_f32 v52, v52, v79
  v_cvt_pk_bf16_f32 v77, v78, v79
  ds_write_b64 v33, v[76:77] offset:16384
  v_mfma_f32_16x16x32_bf16 v[64:67], a[204:207], a[76:79], v[64:67]
  v_exp_f32 v80, v80
  v_mfma_f32_16x16x32_bf16 v[64:67], a[208:211], a[100:103], v[64:67]
  v_exp_f32 v81, v81
  v_mfma_f32_16x16x32_bf16 v[64:67], a[212:215], a[124:127], v[64:67]
  buffer_load_dwordx4 v10, s[16:19], s6 offen nt lds
  v_mfma_f32_16x16x32_bf16 v[64:67], a[216:219], a[148:151], v[64:67]
  v_exp_f32 v82, v82
  v_mfma_f32_16x16x32_bf16 v[64:67], a[220:223], a[172:175], v[64:67]
  v_exp_f32 v83, v83
  v_mfma_f32_16x16x32_bf16 v[68:71], a[192:195], a[8:11], 0
  v_add_f32 v53, v53, v80
  v_add_f32 v53, v53, v81
  v_cvt_pk_bf16_f32 v80, v80, v81
  v_add_f32 v53, v53, v82
  v_add_f32 v53, v53, v83
  v_cvt_pk_bf16_f32 v81, v82, v83
  ds_write_b64 v33, v[80:81] offset:17408
  v_mfma_f32_16x16x32_bf16 v[68:71], a[196:199], a[32:35], v[68:71]
  v_add_u32 v97, 6144, v96
  v_add_u32 v98, 12288, v96
  v_mfma_f32_16x16x32_bf16 v[68:71], a[200:203], a[56:59], v[68:71]
  v_add_u32 v99, 18432, v96
  s_add_u32 s81, s64, 65536
  v_mfma_f32_16x16x32_bf16 v[68:71], a[204:207], a[80:83], v[68:71]
  s_waitcnt lgkmcnt(0)
  s_barrier
  buffer_load_dwordx4 v11, s[16:19], s6 offen offset:1024 nt lds
  v_subrev_u32 v92, s81, v25
  v_mfma_f32_16x16x32_bf16 v[68:71], a[208:211], a[104:107], v[68:71]
  ds_read_b128 v[108:111], v34 offset:12288
  v_fma_f32 v60, v60, s94, v54
  v_mfma_f32_16x16x32_bf16 v[68:71], a[212:215], a[128:131], v[68:71]
  ds_read_b128 v[132:135], v34 offset:18432
  v_fma_f32 v61, v61, s94, v54
  v_mfma_f32_16x16x32_bf16 v[68:71], a[216:219], a[152:155], v[68:71]
  v_fma_f32 v62, v62, s94, v54
  v_fma_f32 v63, v63, s94, v54
  v_mfma_f32_16x16x32_bf16 v[68:71], a[220:223], a[176:179], v[68:71]
  v_exp_f32 v60, v60
  v_mfma_f32_16x16x32_bf16 v[72:75], a[192:195], a[12:15], 0
  ds_read_b128 v[112:115], v34 offset:13312
  v_fma_f32 v64, v64, s94, v55
  v_mfma_f32_16x16x32_bf16 v[72:75], a[196:199], a[36:39], v[72:75]
  buffer_load_dwordx4 v12, s[16:19], s6 offen offset:2048 nt lds
  v_fma_f32 v65, v65, s94, v55
  v_mfma_f32_16x16x32_bf16 v[72:75], a[200:203], a[60:63], v[72:75]
L_it2:
  s_cbranch_execz L_it6
  ds_read_b128 v[136:139], v34 offset:19456
  v_fma_f32 v66, v66, s94, v55
  v_mfma_f32_16x16x32_bf16 v[72:75], a[204:207], a[84:87], v[72:75]
  v_exp_f32 v61, v61
  v_mfma_f32_16x16x32_bf16 v[72:75], a[208:211], a[108:111], v[72:75]
  s_waitcnt vmcnt(15)
  ds_read_b64_tr_b16 a[224:225], v25
  v_fma_f32 v67, v67, s94, v55
  v_mfma_f32_16x16x32_bf16 v[72:75], a[212:215], a[132:135], v[72:75]
  ds_read_b128 v[116:119], v34 offset:14336
  v_fma_f32 v68, v68, s94, v56
  v_mfma_f32_16x16x32_bf16 v[72:75], a[216:219], a[156:159], v[72:75]
  ds_read_b64_tr_b16 a[226:227], v25 offset:2048
  v_fma_f32 v69, v69, s94, v56
  v_mfma_f32_16x16x32_bf16 v[72:75], a[220:223], a[180:183], v[72:75]
  buffer_load_dwordx4 v13, s[16:19], s6 offen offset:3072 nt lds
  v_fma_f32 v70, v70, s94, v56
  v_mfma_f32_16x16x32_bf16 v[76:79], a[192:195], a[16:19], 0
  ds_read_b128 v[140:143], v34 offset:20480
  v_fma_f32 v71, v71, s94, v56
  v_mfma_f32_16x16x32_bf16 v[76:79], a[196:199], a[40:43], v[76:79]
  v_exp_f32 v62, v62
  v_mfma_f32_16x16x32_bf16 v[76:79], a[200:203], a[64:67], v[76:79]
  s_waitcnt vmcnt(12)
  ds_read_b128 v[120:123], v34 offset:15360
  s_add_u32 m0, s65, 12288
  v_mfma_f32_16x16x32_bf16 v[76:79], a[204:207], a[88:91], v[76:79]
  ds_read_b64_tr_b16 a[240:241], v25 offset:4096
  s_xor_b32 s6, s63, 98304
  v_mfma_f32_16x16x32_bf16 v[76:79], a[208:211], a[112:115], v[76:79]
  ds_read_b128 v[144:147], v34 offset:21504
  v_fma_f32 v72, v72, s94, v57
  v_mfma_f32_16x16x32_bf16 v[76:79], a[212:215], a[136:139], v[76:79]
  buffer_load_dwordx4 v10, s[16:19], s6 offen nt lds
  v_fma_f32 v73, v73, s94, v57
  v_mfma_f32_16x16x32_bf16 v[76:79], a[216:219], a[160:163], v[76:79]
  ds_read_b64_tr_b16 a[242:243], v25 offset:6144
  v_fma_f32 v74, v74, s94, v57
  v_mfma_f32_16x16x32_bf16 v[76:79], a[220:223], a[184:187], v[76:79]
  ds_read_b128 v[124:127], v34 offset:16384
  v_fma_f32 v75, v75, s94, v57
  v_mfma_f32_16x16x32_bf16 v[80:83], a[192:195], a[20:23], 0
  ds_read_b64_tr_b16 a[228:229], v26
  v_subrev_u32 v93, s81, v26
  v_mfma_f32_16x16x32_bf16 v[80:83], a[196:199], a[44:47], v[80:83]
  ds_read_b128 v[148:151], v34 offset:22528
  v_subrev_u32 v94, s81, v27
  v_mfma_f32_16x16x32_bf16 v[80:83], a[200:203], a[68:71], v[80:83]
  ds_read_b64_tr_b16 a[230:231], v26 offset:2048
  v_subrev_u32 v95, s81, v28
  v_mfma_f32_16x16x32_bf16 v[80:83], a[204:207], a[92:95], v[80:83]
  buffer_load_dwordx4 v11, s[16:19], s6 offen offset:1024 nt lds
  s_mul_i32 s81, s56, 6144
  v_mfma_f32_16x16x32_bf16 v[80:83], a[208:211], a[116:119], v[80:83]
  ds_read_b128 v[128:131], v34 offset:17408
  v_fma_f32 v76, v76, s94, v58
  v_mfma_f32_16x16x32_bf16 v[80:83], a[212:215], a[140:143], v[80:83]
  v_exp_f32 v63, v63
  v_mfma_f32_16x16x32_bf16 v[80:83], a[216:219], a[164:167], v[80:83]
  ds_read_b128 v[152:155], v34 offset:23552
  v_add_f32 v48, v48, v60
  v_mfma_f32_16x16x32_bf16 v[80:83], a[220:223], a[188:191], v[80:83]
  ds_read_b64_tr_b16 a[244:245], v26 offset:4096
  v_add_f32 v48, v48, v61
  s_waitcnt lgkmcnt(12)
  v_mfma_f32_16x16x32_bf16 v[156:159], a[224:227], v[108:111], v[156:159]
  ds_read_b64_tr_b16 a[246:247], v26 offset:6144
  v_cvt_pk_bf16_f32 v60, v60, v61
  s_waitcnt lgkmcnt(8)
  v_mfma_f32_16x16x32_bf16 v[156:159], a[240:243], v[132:135], v[156:159]
  buffer_load_dwordx4 v12, s[16:19], s6 offen offset:2048 nt lds
  v_add_f32 v48, v48, v62
  v_mfma_f32_16x16x32_bf16 v[172:175], a[224:227], v[112:115], v[172:175]
  v_add_f32 v48, v48, v63
  v_cvt_pk_bf16_f32 v61, v62, v63
  v_mfma_f32_16x16x32_bf16 v[172:175], a[240:243], v[136:139], v[172:175]
  ds_write_b64 v33, v[60:61]
  v_mfma_f32_16x16x32_bf16 v[188:191], a[224:227], v[116:119], v[188:191]
  ds_read_b64_tr_b16 a[232:233], v27
  v_fma_f32 v77, v77, s94, v58
  v_mfma_f32_16x16x32_bf16 v[188:191], a[240:243], v[140:143], v[188:191]
  v_exp_f32 v64, v64
  v_mfma_f32_16x16x32_bf16 v[204:207], a[224:227], v[120:123], v[204:207]
  ds_read_b64_tr_b16 a[234:235], v27 offset:2048
  v_fma_f32 v78, v78, s94, v58
  v_mfma_f32_16x16x32_bf16 v[204:207], a[240:243], v[144:147], v[204:207]
  buffer_load_dwordx4 v13, s[16:19], s6 offen offset:3072 nt lds
  v_fma_f32 v79, v79, s94, v58
  s_waitcnt lgkmcnt(10)
  v_mfma_f32_16x16x32_bf16 v[220:223], a[224:227], v[124:127], v[220:223]
  v_exp_f32 v65, v65
  s_waitcnt lgkmcnt(8)
  v_mfma_f32_16x16x32_bf16 v[220:223], a[240:243], v[148:151], v[220:223]
  v_exp_f32 v66, v66
  s_waitcnt lgkmcnt(6)
  v_mfma_f32_16x16x32_bf16 v[236:239], a[224:227], v[128:131], v[236:239]
  v_exp_f32 v67, v67
  s_waitcnt lgkmcnt(5)
  v_mfma_f32_16x16x32_bf16 v[236:239], a[240:243], v[152:155], v[236:239]
  ds_read_b64_tr_b16 a[248:249], v27 offset:4096
  s_add_u32 m0, s64, 0
  v_mfma_f32_16x16x32_bf16 v[160:163], a[228:231], v[108:111], v[160:163]
  ds_read_b64_tr_b16 a[250:251], v27 offset:6144
  s_xor_b32 s6, s62, 131072
  s_waitcnt lgkmcnt(5)
  v_mfma_f32_16x16x32_bf16 v[160:163], a[244:247], v[132:135], v[160:163]
  v_add_f32 v49, v49, v64
  v_add_f32 v49, v49, v65
  v_mfma_f32_16x16x32_bf16 v[176:179], a[228:231], v[112:115], v[176:179]
  buffer_load_dwordx4 v2, s[12:15], s6 offen nt lds
  v_cvt_pk_bf16_f32 v64, v64, v65
  v_mfma_f32_16x16x32_bf16 v[176:179], a[244:247], v[136:139], v[176:179]
  v_add_f32 v49, v49, v66
  v_add_f32 v49, v49, v67
  v_mfma_f32_16x16x32_bf16 v[192:195], a[228:231], v[116:119], v[192:195]
  ds_read_b64_tr_b16 a[236:237], v28
  v_cvt_pk_bf16_f32 v65, v66, v67
  ds_write_b64 v33, v[64:65] offset:1024
  v_mfma_f32_16x16x32_bf16 v[192:195], a[244:247], v[140:143], v[192:195]
  v_exp_f32 v68, v68
  v_mfma_f32_16x16x32_bf16 v[208:211], a[228:231], v[120:123], v[208:211]
  ds_read_b64_tr_b16 a[238:239], v28 offset:2048
  v_fma_f32 v80, v80, s94, v59
  v_mfma_f32_16x16x32_bf16 v[208:211], a[244:247], v[144:147], v[208:211]
  v_exp_f32 v69, v69
  v_mfma_f32_16x16x32_bf16 v[224:227], a[228:231], v[124:127], v[224:227]
  buffer_load_dwordx4 v3, s[12:15], s6 offen offset:1024 nt lds
  v_fma_f32 v81, v81, s94, v59
  v_mfma_f32_16x16x32_bf16 v[224:227], a[244:247], v[148:151], v[224:227]
  v_exp_f32 v70, v70
  v_mfma_f32_16x16x32_bf16 v[240:243], a[228:231], v[128:131], v[240:243]
  v_exp_f32 v71, v71
  v_mfma_f32_16x16x32_bf16 v[240:243], a[244:247], v[152:155], v[240:243]
  ds_read_b64_tr_b16 a[252:253], v28 offset:4096
  v_add_f32 v50, v50, v68
  s_waitcnt lgkmcnt(6)
  v_mfma_f32_16x16x32_bf16 v[164:167], a[232:235], v[108:111], v[164:167]
  ds_read_b64_tr_b16 a[254:255], v28 offset:6144
  v_add_f32 v50, v50, v69
  s_waitcnt lgkmcnt(5)
  v_mfma_f32_16x16x32_bf16 v[164:167], a[248:251], v[132:135], v[164:167]
  v_cvt_pk_bf16_f32 v68, v68, v69
  v_add_f32 v50, v50, v70
  v_mfma_f32_16x16x32_bf16 v[180:183], a[232:235], v[112:115], v[180:183]
  buffer_load_dwordx4 v4, s[12:15], s6 offen offset:2048 nt lds
  v_add_f32 v50, v50, v71
  v_mfma_f32_16x16x32_bf16 v[180:183], a[248:251], v[136:139], v[180:183]
  v_cvt_pk_bf16_f32 v69, v70, v71
  v_fma_f32 v82, v82, s94, v59
  v_mfma_f32_16x16x32_bf16 v[196:199], a[232:235], v[116:119], v[196:199]
  ds_write_b64 v33, v[68:69] offset:2048
  v_mfma_f32_16x16x32_bf16 v[196:199], a[248:251], v[140:143], v[196:199]
  s_waitcnt vmcnt(11)
  v_exp_f32 v72, v72
  v_mfma_f32_16x16x32_bf16 v[212:215], a[232:235], v[120:123], v[212:215]
  v_exp_f32 v73, v73
  v_mfma_f32_16x16x32_bf16 v[212:215], a[248:251], v[144:147], v[212:215]
  v_exp_f32 v74, v74
  v_mfma_f32_16x16x32_bf16 v[228:231], a[232:235], v[124:127], v[228:231]
  buffer_load_dwordx4 v5, s[12:15], s6 offen offset:3072 nt lds
  v_fma_f32 v83, v83, s94, v59
  v_mfma_f32_16x16x32_bf16 v[228:231], a[248:251], v[148:151], v[228:231]
  v_exp_f32 v75, v75
  v_mfma_f32_16x16x32_bf16 v[244:247], a[232:235], v[128:131], v[244:247]
  ds_read_b128 a[192:195], v21 offset:32768
  v_add_f32 v51, v51, v72
  v_mfma_f32_16x16x32_bf16 v[244:247], a[248:251], v[152:155], v[244:247]
  ds_read_b128 a[196:199], v22 offset:32768
  s_add_u32 m0, s64, 4096
  s_waitcnt lgkmcnt(5)
  v_mfma_f32_16x16x32_bf16 v[168:171], a[236:239], v[108:111], v[168:171]
  ds_read_b128 a[200:203], v23 offset:32768
  v_add_f32 v51, v51, v73
  s_waitcnt lgkmcnt(4)
  v_mfma_f32_16x16x32_bf16 v[168:171], a[252:255], v[132:135], v[168:171]
  ds_read_b128 a[204:207], v24 offset:32768
  v_cvt_pk_bf16_f32 v72, v72, v73
  v_mfma_f32_16x16x32_bf16 v[184:187], a[236:239], v[112:115], v[184:187]
  buffer_load_dwordx4 v6, s[12:15], s6 offen nt lds
  v_add_f32 v51, v51, v74
  v_mfma_f32_16x16x32_bf16 v[184:187], a[252:255], v[136:139], v[184:187]
  ds_read_b128 a[208:211], v21 offset:33024
  v_add_f32 v51, v51, v75
  v_mfma_f32_16x16x32_bf16 v[200:203], a[236:239], v[116:119], v[200:203]
  ds_read_b128 a[212:215], v22 offset:33024
  v_cvt_pk_bf16_f32 v73, v74, v75
  ds_write_b64 v33, v[72:73] offset:3072
  v_mfma_f32_16x16x32_bf16 v[200:203], a[252:255], v[140:143], v[200:203]
  ds_read_b128 a[216:219], v23 offset:33024
  v_add_u32 v42, s81, v34
  v_mfma_f32_16x16x32_bf16 v[216:219], a[236:239], v[120:123], v[216:219]
  s_lshl2_add_u32 s81, s56, 155648
  v_exp_f32 v76, v76
  v_mfma_f32_16x16x32_bf16 v[216:219], a[252:255], v[144:147], v[216:219]
  ds_read_b128 a[220:223], v24 offset:33024
  v_add_u32 v36, s81, v35
  v_mfma_f32_16x16x32_bf16 v[232:235], a[236:239], v[124:127], v[232:235]
  buffer_load_dwordx4 v7, s[12:15], s6 offen offset:1024 nt lds
  v_add_u32 v37, 155648, v38
  v_mfma_f32_16x16x32_bf16 v[232:235], a[252:255], v[148:151], v[232:235]
  s_mul_i32 s83, s61, 229376
  v_exp_f32 v77, v77
  v_mfma_f32_16x16x32_bf16 v[248:251], a[236:239], v[128:131], v[248:251]
  s_lshl_b32 s82, s56, 8
  v_exp_f32 v78, v78
  v_mfma_f32_16x16x32_bf16 v[248:251], a[252:255], v[152:155], v[248:251]
  s_add_u32 s83, s83, s82
  v_exp_f32 v79, v79
  s_waitcnt lgkmcnt(8)
  v_mfma_f32_16x16x32_bf16 v[60:63], a[192:195], a[0:3], 0
  v_add_f32 v52, v52, v76
  v_add_f32 v52, v52, v77
  s_waitcnt lgkmcnt(7)
  v_mfma_f32_16x16x32_bf16 v[60:63], a[196:199], a[24:27], v[60:63]
  v_cvt_pk_bf16_f32 v76, v76, v77
  v_add_f32 v52, v52, v78
  s_waitcnt lgkmcnt(6)
  v_mfma_f32_16x16x32_bf16 v[60:63], a[200:203], a[48:51], v[60:63]
  buffer_load_dwordx4 v8, s[12:15], s6 offen offset:2048 nt lds
  v_add_f32 v52, v52, v79
  s_waitcnt lgkmcnt(5)
  v_mfma_f32_16x16x32_bf16 v[60:63], a[204:207], a[72:75], v[60:63]
  v_cvt_pk_bf16_f32 v77, v78, v79
  v_and_b32 v43, 1, v1
  s_waitcnt lgkmcnt(4)
  v_mfma_f32_16x16x32_bf16 v[60:63], a[208:211], a[96:99], v[60:63]
  ds_write_b64 v33, v[76:77] offset:4096
  s_waitcnt lgkmcnt(4)
  v_mfma_f32_16x16x32_bf16 v[60:63], a[212:215], a[120:123], v[60:63]
  v_exp_f32 v80, v80
  s_waitcnt lgkmcnt(2)
  v_mfma_f32_16x16x32_bf16 v[60:63], a[216:219], a[144:147], v[60:63]
  v_exp_f32 v81, v81
  s_waitcnt lgkmcnt(1)
  v_mfma_f32_16x16x32_bf16 v[60:63], a[220:223], a[168:171], v[60:63]
  v_exp_f32 v82, v82
  v_mfma_f32_16x16x32_bf16 v[64:67], a[192:195], a[4:7], 0
  buffer_load_dwordx4 v9, s[12:15], s6 offen offset:3072 nt lds
  v_lshlrev_b32 v43, 4, v43
  v_mfma_f32_16x16x32_bf16 v[64:67], a[196:199], a[28:31], v[64:67]
  v_exp_f32 v83, v83
  v_mfma_f32_16x16x32_bf16 v[64:67], a[200:203], a[52:55], v[64:67]
  v_add_f32 v53, v53, v80
  v_add_f32 v53, v53, v81
  v_mfma_f32_16x16x32_bf16 v[64:67], a[204:207], a[76:79], v[64:67]
  v_cvt_pk_bf16_f32 v80, v80, v81
  v_add_f32 v53, v53, v82
  v_mfma_f32_16x16x32_bf16 v[64:67], a[208:211], a[100:103], v[64:67]
  s_add_u32 m0, s65, 0
  s_xor_b32 s6, s63, 73728
  v_add_f32 v53, v53, v83
  v_mfma_f32_16x16x32_bf16 v[64:67], a[212:215], a[124:127], v[64:67]
  v_cvt_pk_bf16_f32 v81, v82, v83
  v_mov_b32 v44, 0x3f80
  v_mfma_f32_16x16x32_bf16 v[64:67], a[216:219], a[148:151], v[64:67]
  ds_write_b64 v33, v[80:81] offset:5120
  v_mfma_f32_16x16x32_bf16 v[64:67], a[220:223], a[172:175], v[64:67]
  buffer_load_dwordx4 v10, s[16:19], s6 offen nt lds
  v_lshlrev_b32 v43, v43, v44
  v_mfma_f32_16x16x32_bf16 v[68:71], a[192:195], a[8:11], 0
  v_bfe_u32 v44, v1, 1, 3
  v_lshrrev_b32 v45, 4, v1
  v_mfma_f32_16x16x32_bf16 v[68:71], a[196:199], a[32:35], v[68:71]
  v_lshlrev_b32 v45, 1, v45
  v_mfma_f32_16x16x32_bf16 v[68:71], a[200:203], a[56:59], v[68:71]
  v_cmp_eq_u32 vcc, v44, v45
  s_nop 3
  v_cndmask_b32 v86, 0, v43, vcc
  v_add_u32 v45, 1, v45
  v_mfma_f32_16x16x32_bf16 v[68:71], a[204:207], a[80:83], v[68:71]
  s_waitcnt lgkmcnt(0)
  s_barrier
  v_cmp_eq_u32 vcc, v44, v45
  s_nop 3
  v_cndmask_b32 v87, 0, v43, vcc
  ds_read_b128 v[108:111], v34
  v_mov_b32 v84, 0
  v_mfma_f32_16x16x32_bf16 v[68:71], a[208:211], a[104:107], v[68:71]
  v_fma_f32 v60, v60, s94, v54
  v_fma_f32 v61, v61, s94, v54
  v_mfma_f32_16x16x32_bf16 v[68:71], a[212:215], a[128:131], v[68:71]
  buffer_load_dwordx4 v11, s[16:19], s6 offen offset:1024 nt lds
  v_fma_f32 v62, v62, s94, v54
  v_mfma_f32_16x16x32_bf16 v[68:71], a[216:219], a[152:155], v[68:71]
  ds_read_b128 v[132:135], v34 offset:6144
  v_fma_f32 v63, v63, s94, v54
  v_mfma_f32_16x16x32_bf16 v[68:71], a[220:223], a[176:179], v[68:71]
  v_exp_f32 v60, v60
  v_mfma_f32_16x16x32_bf16 v[72:75], a[192:195], a[12:15], 0
  ds_read_b128 v[112:115], v34 offset:1024
  v_fma_f32 v64, v64, s94, v55
  v_mfma_f32_16x16x32_bf16 v[72:75], a[196:199], a[36:39], v[72:75]
  v_exp_f32 v61, v61
  v_mfma_f32_16x16x32_bf16 v[72:75], a[200:203], a[60:63], v[72:75]
  ds_read_b128 v[136:139], v34 offset:7168
  v_fma_f32 v65, v65, s94, v55
  v_mfma_f32_16x16x32_bf16 v[72:75], a[204:207], a[84:87], v[72:75]
  buffer_load_dwordx4 v12, s[16:19], s6 offen offset:2048 nt lds
  v_fma_f32 v66, v66, s94, v55
  v_mfma_f32_16x16x32_bf16 v[72:75], a[208:211], a[108:111], v[72:75]
  s_waitcnt vmcnt(15)
  ds_read_b64_tr_b16 a[224:225], v25 offset:8192
  v_fma_f32 v67, v67, s94, v55
  v_mfma_f32_16x16x32_bf16 v[72:75], a[212:215], a[132:135], v[72:75]
  ds_read_b128 v[116:119], v34 offset:2048
  v_fma_f32 v68, v68, s94, v56
  v_mfma_f32_16x16x32_bf16 v[72:75], a[216:219], a[156:159], v[72:75]
  ds_read_b64_tr_b16 a[226:227], v25 offset:10240
  v_fma_f32 v69, v69, s94, v56
  v_mfma_f32_16x16x32_bf16 v[72:75], a[220:223], a[180:183], v[72:75]
  ds_read_b128 v[140:143], v34 offset:8192
  v_fma_f32 v70, v70, s94, v56
  v_mfma_f32_16x16x32_bf16 v[76:79], a[192:195], a[16:19], 0
  v_exp_f32 v62, v62
  v_mfma_f32_16x16x32_bf16 v[76:79], a[196:199], a[40:43], v[76:79]
  buffer_load_dwordx4 v13, s[16:19], s6 offen offset:3072 nt lds
  v_fma_f32 v71, v71, s94, v56
  v_mfma_f32_16x16x32_bf16 v[76:79], a[200:203], a[64:67], v[76:79]
  s_waitcnt vmcnt(12)
  ds_read_b128 v[120:123], v34 offset:3072
  v_mov_b32 v85, 0
  v_mfma_f32_16x16x32_bf16 v[76:79], a[204:207], a[88:91], v[76:79]
  ds_read_b64_tr_b16 a[240:241], v25 offset:12288
  v_mov_b32 v88, 0
  v_mfma_f32_16x16x32_bf16 v[76:79], a[208:211], a[112:115], v[76:79]
  ds_read_b128 v[144:147], v34 offset:9216
  s_add_u32 m0, s65, 4096
  v_mfma_f32_16x16x32_bf16 v[76:79], a[212:215], a[136:139], v[76:79]
  ds_read_b64_tr_b16 a[242:243], v25 offset:14336
  s_xor_b32 s6, s63, 106496
  v_mfma_f32_16x16x32_bf16 v[76:79], a[216:219], a[160:163], v[76:79]
  v_exp_f32 v63, v63
  v_mfma_f32_16x16x32_bf16 v[76:79], a[220:223], a[184:187], v[76:79]
  buffer_load_dwordx4 v10, s[16:19], s6 offen nt lds
  v_add_f32 v48, v48, v60
  v_mfma_f32_16x16x32_bf16 v[80:83], a[192:195], a[20:23], 0
  ds_read_b64_tr_b16 a[228:229], v26 offset:8192
  v_add_f32 v48, v48, v61
  v_mfma_f32_16x16x32_bf16 v[80:83], a[196:199], a[44:47], v[80:83]
  ds_read_b128 v[124:127], v34 offset:4096
  v_cvt_pk_bf16_f32 v60, v60, v61
  v_mfma_f32_16x16x32_bf16 v[80:83], a[200:203], a[68:71], v[80:83]
  ds_read_b64_tr_b16 a[230:231], v26 offset:10240
  v_add_f32 v48, v48, v62
  v_mfma_f32_16x16x32_bf16 v[80:83], a[204:207], a[92:95], v[80:83]
  ds_read_b128 v[148:151], v34 offset:10240
  v_add_f32 v48, v48, v63
  v_mfma_f32_16x16x32_bf16 v[80:83], a[208:211], a[116:119], v[80:83]
  ds_read_b128 v[128:131], v34 offset:5120
  v_cvt_pk_bf16_f32 v61, v62, v63
  v_mfma_f32_16x16x32_bf16 v[80:83], a[212:215], a[140:143], v[80:83]
  buffer_load_dwordx4 v11, s[16:19], s6 offen offset:1024 nt lds
  v_fma_f32 v72, v72, s94, v57
  v_mfma_f32_16x16x32_bf16 v[80:83], a[216:219], a[164:167], v[80:83]
  ds_read_b128 v[152:155], v34 offset:11264
  v_fma_f32 v73, v73, s94, v57
  v_mfma_f32_16x16x32_bf16 v[80:83], a[220:223], a[188:191], v[80:83]
  ds_write_b64 v33, v[60:61] offset:12288
  s_waitcnt lgkmcnt(12)
  v_mfma_f32_16x16x32_bf16 v[156:159], a[224:227], v[108:111], v[156:159]
  ds_read_b64_tr_b16 a[244:245], v26 offset:12288
  v_fma_f32 v74, v74, s94, v57
  s_waitcnt lgkmcnt(8)
  v_mfma_f32_16x16x32_bf16 v[156:159], a[240:243], v[132:135], v[156:159]
  ds_read_b64_tr_b16 a[246:247], v26 offset:14336
  v_fma_f32 v75, v75, s94, v57
  v_mfma_f32_16x16x32_bf16 v[172:175], a[224:227], v[112:115], v[172:175]
  v_exp_f32 v64, v64
  v_mfma_f32_16x16x32_bf16 v[172:175], a[240:243], v[136:139], v[172:175]
  buffer_load_dwordx4 v12, s[16:19], s6 offen offset:2048 nt lds
  v_fma_f32 v76, v76, s94, v58
  v_mfma_f32_16x16x32_bf16 v[188:191], a[224:227], v[116:119], v[188:191]
  ds_read_b64_tr_b16 a[232:233], v27 offset:8192
  v_fma_f32 v77, v77, s94, v58
  v_mfma_f32_16x16x32_bf16 v[188:191], a[240:243], v[140:143], v[188:191]
  v_exp_f32 v65, v65
  v_mfma_f32_16x16x32_bf16 v[204:207], a[224:227], v[120:123], v[204:207]
  ds_read_b64_tr_b16 a[234:235], v27 offset:10240
  v_fma_f32 v78, v78, s94, v58
  v_mfma_f32_16x16x32_bf16 v[204:207], a[240:243], v[144:147], v[204:207]
  v_exp_f32 v66, v66
  s_waitcnt lgkmcnt(9)
  v_mfma_f32_16x16x32_bf16 v[220:223], a[224:227], v[124:127], v[220:223]
  v_exp_f32 v67, v67
  s_waitcnt lgkmcnt(7)
  v_mfma_f32_16x16x32_bf16 v[220:223], a[240:243], v[148:151], v[220:223]
  buffer_load_dwordx4 v13, s[16:19], s6 offen offset:3072 nt lds
  v_add_f32 v49, v49, v64
  s_waitcnt lgkmcnt(6)
  v_mfma_f32_16x16x32_bf16 v[236:239], a[224:227], v[128:131], v[236:239]
  ds_read_b64_tr_b16 a[248:249], v27 offset:12288
  v_add_f32 v49, v49, v65
  s_waitcnt lgkmcnt(6)
  v_mfma_f32_16x16x32_bf16 v[236:239], a[240:243], v[152:155], v[236:239]
  v_cvt_pk_bf16_f32 v64, v64, v65
  v_add_f32 v49, v49, v66
  v_mfma_f32_16x16x32_bf16 v[160:163], a[228:231], v[108:111], v[160:163]
  ds_read_b64_tr_b16 a[250:251], v27 offset:14336
  v_add_f32 v49, v49, v67
  s_waitcnt lgkmcnt(4)
  v_mfma_f32_16x16x32_bf16 v[160:163], a[244:247], v[132:135], v[160:163]
  s_add_u32 m0, s64, 32768
  s_xor_b32 s6, s62, 139264
  v_cvt_pk_bf16_f32 v65, v66, v67
  v_mfma_f32_16x16x32_bf16 v[176:179], a[228:231], v[112:115], v[176:179]
  ds_write_b64 v33, v[64:65] offset:13312
  v_mfma_f32_16x16x32_bf16 v[176:179], a[244:247], v[136:139], v[176:179]
  v_exp_f32 v68, v68
  v_mfma_f32_16x16x32_bf16 v[192:195], a[228:231], v[116:119], v[192:195]
  buffer_load_dwordx4 v2, s[12:15], s6 offen nt lds
  v_fma_f32 v79, v79, s94, v58
  v_mfma_f32_16x16x32_bf16 v[192:195], a[244:247], v[140:143], v[192:195]
  ds_read_b64_tr_b16 a[236:237], v28 offset:8192
  v_fma_f32 v80, v80, s94, v59
  v_mfma_f32_16x16x32_bf16 v[208:211], a[228:231], v[120:123], v[208:211]
  ds_read_b64_tr_b16 a[238:239], v28 offset:10240
  v_fma_f32 v81, v81, s94, v59
  v_mfma_f32_16x16x32_bf16 v[208:211], a[244:247], v[144:147], v[208:211]
  v_exp_f32 v69, v69
  v_mfma_f32_16x16x32_bf16 v[224:227], a[228:231], v[124:127], v[224:227]
  v_exp_f32 v70, v70
  v_mfma_f32_16x16x32_bf16 v[224:227], a[244:247], v[148:151], v[224:227]
  v_exp_f32 v71, v71
  v_mfma_f32_16x16x32_bf16 v[240:243], a[228:231], v[128:131], v[240:243]
  buffer_load_dwordx4 v3, s[12:15], s6 offen offset:1024 nt lds
  v_add_f32 v50, v50, v68
  v_mfma_f32_16x16x32_bf16 v[240:243], a[244:247], v[152:155], v[240:243]
  ds_read_b64_tr_b16 a[252:253], v28 offset:12288
  v_add_f32 v50, v50, v69
  s_waitcnt lgkmcnt(6)
  v_mfma_f32_16x16x32_bf16 v[164:167], a[232:235], v[108:111], v[164:167]
  ds_read_b64_tr_b16 a[254:255], v28 offset:14336
  v_cvt_pk_bf16_f32 v68, v68, v69
  s_waitcnt lgkmcnt(5)
  v_mfma_f32_16x16x32_bf16 v[164:167], a[248:251], v[132:135], v[164:167]
  v_add_f32 v50, v50, v70
  v_add_f32 v50, v50, v71
  v_mfma_f32_16x16x32_bf16 v[180:183], a[232:235], v[112:115], v[180:183]
  v_cvt_pk_bf16_f32 v69, v70, v71
  v_fma_f32 v82, v82, s94, v59
  v_mfma_f32_16x16x32_bf16 v[180:183], a[248:251], v[136:139], v[180:183]
  ds_write_b64 v33, v[68:69] offset:14336
  v_mfma_f32_16x16x32_bf16 v[196:199], a[232:235], v[116:119], v[196:199]
  buffer_load_dwordx4 v4, s[12:15], s6 offen offset:2048 nt lds
  v_fma_f32 v83, v83, s94, v59
  v_mfma_f32_16x16x32_bf16 v[196:199], a[248:251], v[140:143], v[196:199]
  s_waitcnt vmcnt(11)
  v_exp_f32 v72, v72
  v_mfma_f32_16x16x32_bf16 v[212:215], a[232:235], v[120:123], v[212:215]
  v_exp_f32 v73, v73
  v_mfma_f32_16x16x32_bf16 v[212:215], a[248:251], v[144:147], v[212:215]
  v_exp_f32 v74, v74
  v_mfma_f32_16x16x32_bf16 v[228:231], a[232:235], v[124:127], v[228:231]
  v_exp_f32 v75, v75
  v_mfma_f32_16x16x32_bf16 v[228:231], a[248:251], v[148:151], v[228:231]
  ds_read_b128 a[192:195], v21
  v_add_f32 v51, v51, v72
  v_mfma_f32_16x16x32_bf16 v[244:247], a[232:235], v[128:131], v[244:247]
  buffer_load_dwordx4 v5, s[12:15], s6 offen offset:3072 nt lds
  v_add_f32 v51, v51, v73
  v_mfma_f32_16x16x32_bf16 v[244:247], a[248:251], v[152:155], v[244:247]
  ds_read_b128 a[196:199], v22
  v_cvt_pk_bf16_f32 v72, v72, v73
  s_waitcnt lgkmcnt(5)
  v_mfma_f32_16x16x32_bf16 v[168:171], a[236:239], v[108:111], v[168:171]
  ds_read_b128 a[200:203], v23
  v_add_f32 v51, v51, v74
  s_waitcnt lgkmcnt(4)
  v_mfma_f32_16x16x32_bf16 v[168:171], a[252:255], v[132:135], v[168:171]
  ds_read_b128 a[204:207], v24
  s_add_u32 m0, s64, 36864
  v_mfma_f32_16x16x32_bf16 v[184:187], a[236:239], v[112:115], v[184:187]
  ds_read_b128 a[208:211], v21 offset:256
  v_add_f32 v51, v51, v75
  v_mfma_f32_16x16x32_bf16 v[184:187], a[252:255], v[136:139], v[184:187]
  ds_read_b128 a[212:215], v22 offset:256
  v_cvt_pk_bf16_f32 v73, v74, v75
  v_mfma_f32_16x16x32_bf16 v[200:203], a[236:239], v[116:119], v[200:203]
  buffer_load_dwordx4 v6, s[12:15], s6 offen nt lds
  v_mov_b32 v89, 0
  ds_write_b64 v33, v[72:73] offset:15360
  v_mfma_f32_16x16x32_bf16 v[200:203], a[252:255], v[140:143], v[200:203]
  ds_read_b128 a[216:219], v23 offset:256
  s_lshl4_add_u32 s81, s58, s61
  v_mfma_f32_16x16x32_bf16 v[216:219], a[236:239], v[120:123], v[216:219]
  s_lshl1_add_u32 s81, s81, s60
  v_exp_f32 v76, v76
  v_mfma_f32_16x16x32_bf16 v[216:219], a[252:255], v[144:147], v[216:219]
  ds_read_b128 a[220:223], v24 offset:256
  s_lshl2_add_u32 s81, s81, s56
  v_mfma_f32_16x16x32_bf16 v[232:235], a[236:239], v[124:127], v[232:235]
  s_xor_b32 s82, s81, 4
  v_exp_f32 v77, v77
  v_mfma_f32_16x16x32_bf16 v[232:235], a[252:255], v[148:151], v[232:235]
  s_mul_i32 s3, s58, 32768
  v_exp_f32 v78, v78
  v_mfma_f32_16x16x32_bf16 v[248:251], a[236:239], v[128:131], v[248:251]
  buffer_load_dwordx4 v7, s[12:15], s6 offen offset:1024 nt lds
  s_and_b32 s95, s81, 127
  v_mfma_f32_16x16x32_bf16 v[248:251], a[252:255], v[152:155], v[248:251]
  s_xor_b32 s95, s95, 0
  v_exp_f32 v79, v79
  s_waitcnt lgkmcnt(8)
  v_mfma_f32_16x16x32_bf16 v[60:63], a[192:195], a[0:3], 0
  s_mul_i32 s88, s95, 128
  v_add_f32 v52, v52, v76
  v_add_f32 v52, v52, v77
  s_waitcnt lgkmcnt(7)
  v_mfma_f32_16x16x32_bf16 v[60:63], a[196:199], a[24:27], v[60:63]
  s_add_u32 s88, s88, s3
  v_cvt_pk_bf16_f32 v76, v76, v77
  v_add_f32 v52, v52, v78
  s_waitcnt lgkmcnt(6)
  v_mfma_f32_16x16x32_bf16 v[60:63], a[200:203], a[48:51], v[60:63]
  s_xor_b32 s95, s95, 4
  v_add_f32 v52, v52, v79
  v_cvt_pk_bf16_f32 v77, v78, v79
  s_waitcnt lgkmcnt(5)
  v_mfma_f32_16x16x32_bf16 v[60:63], a[204:207], a[72:75], v[60:63]
  ds_write_b64 v33, v[76:77] offset:16384
  s_waitcnt lgkmcnt(5)
  v_mfma_f32_16x16x32_bf16 v[60:63], a[208:211], a[96:99], v[60:63]
  buffer_load_dwordx4 v8, s[12:15], s6 offen offset:2048 nt lds
  s_mul_i32 s89, s95, 128
  s_waitcnt lgkmcnt(4)
  v_mfma_f32_16x16x32_bf16 v[60:63], a[212:215], a[120:123], v[60:63]
  s_add_u32 s89, s89, s3
  v_exp_f32 v80, v80
  s_waitcnt lgkmcnt(2)
  v_mfma_f32_16x16x32_bf16 v[60:63], a[216:219], a[144:147], v[60:63]
  s_mul_i32 s84, s81, 6144
  v_exp_f32 v81, v81
  s_waitcnt lgkmcnt(1)
  v_mfma_f32_16x16x32_bf16 v[60:63], a[220:223], a[168:171], v[60:63]
  s_mul_i32 s85, s82, 6144
  v_exp_f32 v82, v82
  v_mfma_f32_16x16x32_bf16 v[64:67], a[192:195], a[4:7], 0
  s_add_u32 s84, s84, 23068672
  v_exp_f32 v83, v83
  v_mfma_f32_16x16x32_bf16 v[64:67], a[196:199], a[28:31], v[64:67]
  s_add_u32 s85, s85, 23068672
  v_add_f32 v53, v53, v80
  v_add_f32 v53, v53, v81
  v_mfma_f32_16x16x32_bf16 v[64:67], a[200:203], a[52:55], v[64:67]
  buffer_load_dwordx4 v9, s[12:15], s6 offen offset:3072 nt lds
  v_cvt_pk_bf16_f32 v80, v80, v81
  v_mfma_f32_16x16x32_bf16 v[64:67], a[204:207], a[76:79], v[64:67]
  s_mul_i32 s86, s81, 512
  v_add_f32 v53, v53, v82
  v_add_f32 v53, v53, v83
  v_mfma_f32_16x16x32_bf16 v[64:67], a[208:211], a[100:103], v[64:67]
  s_mul_i32 s87, s82, 512
  v_cvt_pk_bf16_f32 v81, v82, v83
  s_add_u32 s86, s86, 22020096
  v_mfma_f32_16x16x32_bf16 v[64:67], a[212:215], a[124:127], v[64:67]
  ds_write_b64 v33, v[80:81] offset:17408
  v_mfma_f32_16x16x32_bf16 v[64:67], a[216:219], a[148:151], v[64:67]
  s_add_u32 m0, s65, 8192
  s_xor_b32 s6, s63, 131072
  s_add_u32 s87, s87, 22020096
  v_mfma_f32_16x16x32_bf16 v[64:67], a[220:223], a[172:175], v[64:67]
  s_lshl1_add_u32 s81, s58, s60
  s_lshl2_add_u32 s90, s60, s56
  s_add_u32 s90, s90, 64
  v_mfma_f32_16x16x32_bf16 v[68:71], a[192:195], a[8:11], 0
  s_mul_i32 s90, s90, 256
  s_add_u32 s90, s90, s3
  s_mul_i32 s92, s81, 688128
  v_mfma_f32_16x16x32_bf16 v[68:71], a[196:199], a[32:35], v[68:71]
  buffer_load_dwordx4 v10, s[16:19], s6 offen nt lds
  s_add_u32 s92, s92, 8388608
  v_mfma_f32_16x16x32_bf16 v[68:71], a[200:203], a[56:59], v[68:71]
  s_mul_i32 s82, s61, 43008
  s_add_u32 s91, s92, s82
  s_mul_i32 s82, s56, 12288
  v_mfma_f32_16x16x32_bf16 v[68:71], a[204:207], a[80:83], v[68:71]
  s_waitcnt lgkmcnt(0)
  s_barrier
  ds_read_b128 v[108:111], v34 offset:12288
  s_add_u32 s91, s91, s82
  v_mfma_f32_16x16x32_bf16 v[68:71], a[208:211], a[104:107], v[68:71]
  s_lshr_b32 s81, s61, 3
  v_fma_f32 v60, v60, s94, v54
  v_fma_f32 v61, v61, s94, v54
  v_mfma_f32_16x16x32_bf16 v[68:71], a[212:215], a[128:131], v[68:71]
  ds_read_b128 v[132:135], v34 offset:18432
  v_fma_f32 v62, v62, s94, v54
  v_mfma_f32_16x16x32_bf16 v[68:71], a[216:219], a[152:155], v[68:71]
  s_mul_i32 s81, s81, 3
  v_fma_f32 v63, v63, s94, v54
  v_fma_f32 v64, v64, s94, v55
  v_mfma_f32_16x16x32_bf16 v[68:71], a[220:223], a[176:179], v[68:71]
  buffer_load_dwordx4 v11, s[16:19], s6 offen offset:1024 nt lds
  v_fma_f32 v65, v65, s94, v55
  v_mfma_f32_16x16x32_bf16 v[72:75], a[192:195], a[12:15], 0
  ds_read_b128 v[112:115], v34 offset:13312
  v_fma_f32 v66, v66, s94, v55
  v_mfma_f32_16x16x32_bf16 v[72:75], a[196:199], a[36:39], v[72:75]
  s_sub_u32 s81, s61, s81
  v_exp_f32 v60, v60
  v_mfma_f32_16x16x32_bf16 v[72:75], a[200:203], a[60:63], v[72:75]
  ds_read_b128 v[136:139], v34 offset:19456
  v_fma_f32 v67, v67, s94, v55
  v_mfma_f32_16x16x32_bf16 v[72:75], a[204:207], a[84:87], v[72:75]
L_it3:
  s_cbranch_execz L_it7
  s_and_b32 s82, s61, 7
  v_exp_f32 v61, v61
  v_mfma_f32_16x16x32_bf16 v[72:75], a[208:211], a[108:111], v[72:75]
  s_waitcnt vmcnt(14)
  s_cmp_lt_u32 s81, 8
  s_cselect_b32 s95, 16, 8
  s_cselect_b32 s3, 0, 1
  ds_read_b64_tr_b16 a[224:225], v25
  v_fma_f32 v68, v68, s94, v56
  v_mfma_f32_16x16x32_bf16 v[72:75], a[212:215], a[132:135], v[72:75]
  buffer_load_dwordx4 v12, s[16:19], s6 offen offset:2048 nt lds
  v_fma_f32 v69, v69, s94, v56
  v_mfma_f32_16x16x32_bf16 v[72:75], a[216:219], a[156:159], v[72:75]
  ds_read_b64_tr_b16 a[226:227], v25 offset:2048
  v_fma_f32 v70, v70, s94, v56
  v_mfma_f32_16x16x32_bf16 v[72:75], a[220:223], a[180:183], v[72:75]
  ds_read_b128 v[116:119], v34 offset:14336
  v_fma_f32 v71, v71, s94, v56
  v_mfma_f32_16x16x32_bf16 v[76:79], a[192:195], a[16:19], 0
  ds_read_b128 v[140:143], v34 offset:20480
  s_add_u32 s95, s95, s81
  v_mfma_f32_16x16x32_bf16 v[76:79], a[196:199], a[40:43], v[76:79]
  s_cmp_eq_u32 s56, 1
  s_cselect_b32 s95, s95, s61
  s_cselect_b32 s3, s3, 1
  s_cselect_b32 s7, 5, 16
  s_cmp_eq_u32 s56, 3
  s_cselect_b32 s3, 0, s3
  s_cmp_eq_u32 s56, 2
  s_cselect_b32 s7, 0, s7
  s_cmp_lt_u32 s82, s7
  s_cselect_b32 s7, 0, 1
  s_mul_i32 s82, s95, 43
  v_exp_f32 v62, v62
  v_mfma_f32_16x16x32_bf16 v[76:79], a[200:203], a[64:67], v[76:79]
  s_waitcnt vmcnt(11)
  ds_read_b128 v[120:123], v34 offset:15360
  s_lshr_b32 s82, s82, 8
  v_mfma_f32_16x16x32_bf16 v[76:79], a[204:207], a[88:91], v[76:79]
  buffer_load_dwordx4 v13, s[16:19], s6 offen offset:3072 nt lds
  s_mul_i32 s81, s82, 6
  v_mfma_f32_16x16x32_bf16 v[76:79], a[208:211], a[112:115], v[76:79]
  ds_read_b64_tr_b16 a[240:241], v25 offset:4096
  v_fma_f32 v72, v72, s94, v57
  v_mfma_f32_16x16x32_bf16 v[76:79], a[212:215], a[136:139], v[76:79]
  ds_read_b128 v[144:147], v34 offset:21504
  v_fma_f32 v73, v73, s94, v57
  v_mfma_f32_16x16x32_bf16 v[76:79], a[216:219], a[160:163], v[76:79]
  ds_read_b64_tr_b16 a[242:243], v25 offset:6144
  s_add_u32 m0, s65, 12288
  v_mfma_f32_16x16x32_bf16 v[76:79], a[220:223], a[184:187], v[76:79]
  ds_read_b128 v[124:127], v34 offset:16384
  s_xor_b32 s6, s63, 163840
  v_mfma_f32_16x16x32_bf16 v[80:83], a[192:195], a[20:23], 0
  ds_read_b64_tr_b16 a[228:229], v26
  v_fma_f32 v74, v74, s94, v57
  v_mfma_f32_16x16x32_bf16 v[80:83], a[196:199], a[44:47], v[80:83]
  buffer_load_dwordx4 v10, s[16:19], s6 offen nt lds
  v_fma_f32 v75, v75, s94, v57
  v_mfma_f32_16x16x32_bf16 v[80:83], a[200:203], a[68:71], v[80:83]
  ds_read_b64_tr_b16 a[230:231], v26 offset:2048
  s_sub_u32 s95, s95, s81
  v_mfma_f32_16x16x32_bf16 v[80:83], a[204:207], a[92:95], v[80:83]
  ds_read_b128 v[148:151], v34 offset:22528
  s_lshl1_add_u32 s82, s82, s3
  v_mfma_f32_16x16x32_bf16 v[80:83], a[208:211], a[116:119], v[80:83]
  ds_read_b128 v[128:131], v34 offset:17408
  v_fma_f32 v76, v76, s94, v58
  v_mfma_f32_16x16x32_bf16 v[80:83], a[212:215], a[140:143], v[80:83]
  s_lshl3_add_u32 s40, s60, s82
  v_exp_f32 v63, v63
  v_mfma_f32_16x16x32_bf16 v[80:83], a[216:219], a[164:167], v[80:83]
  ds_read_b128 v[152:155], v34 offset:23552
  v_add_f32 v48, v48, v60
  v_mfma_f32_16x16x32_bf16 v[80:83], a[220:223], a[188:191], v[80:83]
  buffer_load_dwordx4 v11, s[16:19], s6 offen offset:1024 nt lds
  v_add_f32 v48, v48, v61
  s_waitcnt lgkmcnt(12)
  v_mfma_f32_16x16x32_bf16 v[156:159], a[224:227], v[108:111], v[156:159]
  ds_read_b64_tr_b16 a[244:245], v26 offset:4096
  v_cvt_pk_bf16_f32 v60, v60, v61
  s_waitcnt lgkmcnt(7)
  v_mfma_f32_16x16x32_bf16 v[156:159], a[240:243], v[132:135], v[156:159]
  ds_read_b64_tr_b16 a[246:247], v26 offset:6144
  v_add_f32 v48, v48, v62
  v_mfma_f32_16x16x32_bf16 v[172:175], a[224:227], v[112:115], v[172:175]
  s_add_u32 s40, s40, 128
  v_add_f32 v48, v48, v63
  v_cvt_pk_bf16_f32 v61, v62, v63
  v_mfma_f32_16x16x32_bf16 v[172:175], a[240:243], v[136:139], v[172:175]
  ds_write_b64 v33, v[60:61]
  v_mfma_f32_16x16x32_bf16 v[188:191], a[224:227], v[116:119], v[188:191]
  ds_read_b64_tr_b16 a[232:233], v27
  v_fma_f32 v77, v77, s94, v58
  v_mfma_f32_16x16x32_bf16 v[188:191], a[240:243], v[140:143], v[188:191]
  buffer_load_dwordx4 v12, s[16:19], s6 offen offset:2048 nt lds
  v_fma_f32 v78, v78, s94, v58
  v_mfma_f32_16x16x32_bf16 v[204:207], a[224:227], v[120:123], v[204:207]
  ds_read_b64_tr_b16 a[234:235], v27 offset:2048
  v_fma_f32 v79, v79, s94, v58
  v_mfma_f32_16x16x32_bf16 v[204:207], a[240:243], v[144:147], v[204:207]
  s_mul_i32 s40, s40, 128
  v_exp_f32 v64, v64
  s_waitcnt lgkmcnt(10)
  v_mfma_f32_16x16x32_bf16 v[220:223], a[224:227], v[124:127], v[220:223]
  s_mul_i32 s81, s58, 32768
  v_exp_f32 v65, v65
  s_waitcnt lgkmcnt(7)
  v_mfma_f32_16x16x32_bf16 v[220:223], a[240:243], v[148:151], v[220:223]
  s_add_u32 s40, s40, s81
  v_exp_f32 v66, v66
  s_waitcnt lgkmcnt(6)
  v_mfma_f32_16x16x32_bf16 v[236:239], a[224:227], v[128:131], v[236:239]
  s_lshl1_add_u32 s81, s58, s60
  v_exp_f32 v67, v67
  s_waitcnt lgkmcnt(5)
  v_mfma_f32_16x16x32_bf16 v[236:239], a[240:243], v[152:155], v[236:239]
  buffer_load_dwordx4 v13, s[16:19], s6 offen offset:3072 nt lds
  v_add_f32 v49, v49, v64
  v_mfma_f32_16x16x32_bf16 v[160:163], a[228:231], v[108:111], v[160:163]
  ds_read_b64_tr_b16 a[248:249], v27 offset:4096
  v_add_f32 v49, v49, v65
  s_waitcnt lgkmcnt(4)
  v_mfma_f32_16x16x32_bf16 v[160:163], a[244:247], v[132:135], v[160:163]
  ds_read_b64_tr_b16 a[250:251], v27 offset:6144
  v_cvt_pk_bf16_f32 v64, v64, v65
  v_mfma_f32_16x16x32_bf16 v[176:179], a[228:231], v[112:115], v[176:179]
  s_mul_i32 s81, s81, 6
  v_add_f32 v49, v49, v66
  v_add_f32 v49, v49, v67
  v_mfma_f32_16x16x32_bf16 v[176:179], a[244:247], v[136:139], v[176:179]
  s_add_u32 m0, s64, 0
  s_xor_b32 s6, s62, 196608
  v_cvt_pk_bf16_f32 v65, v66, v67
  v_mfma_f32_16x16x32_bf16 v[192:195], a[228:231], v[116:119], v[192:195]
  ds_write_b64 v33, v[64:65] offset:1024
  v_mfma_f32_16x16x32_bf16 v[192:195], a[244:247], v[140:143], v[192:195]
  ds_read_b64_tr_b16 a[236:237], v28
  v_fma_f32 v80, v80, s94, v59
  v_mfma_f32_16x16x32_bf16 v[208:211], a[228:231], v[120:123], v[208:211]
  buffer_load_dwordx4 v2, s[12:15], s6 offen nt lds
  v_fma_f32 v81, v81, s94, v59
  v_mfma_f32_16x16x32_bf16 v[208:211], a[244:247], v[144:147], v[208:211]
  ds_read_b64_tr_b16 a[238:239], v28 offset:2048
  v_fma_f32 v82, v82, s94, v59
  v_mfma_f32_16x16x32_bf16 v[224:227], a[228:231], v[124:127], v[224:227]
  s_add_u32 s81, s81, s95
  v_exp_f32 v68, v68
  v_mfma_f32_16x16x32_bf16 v[224:227], a[244:247], v[148:151], v[224:227]
  s_mul_i32 s81, s81, 7168
  v_exp_f32 v69, v69
  v_mfma_f32_16x16x32_bf16 v[240:243], a[228:231], v[128:131], v[240:243]
  s_lshl_b32 s3, s82, 7
  v_exp_f32 v70, v70
  v_mfma_f32_16x16x32_bf16 v[240:243], a[244:247], v[152:155], v[240:243]
  s_add_u32 s81, s81, s3
  v_exp_f32 v71, v71
  s_waitcnt lgkmcnt(5)
  v_mfma_f32_16x16x32_bf16 v[164:167], a[232:235], v[108:111], v[164:167]
  buffer_load_dwordx4 v3, s[12:15], s6 offen offset:1024 nt lds
  v_add_f32 v50, v50, v68
  s_waitcnt lgkmcnt(3)
  v_mfma_f32_16x16x32_bf16 v[164:167], a[248:251], v[132:135], v[164:167]
  ds_read_b64_tr_b16 a[252:253], v28 offset:4096
  v_add_f32 v50, v50, v69
  v_mfma_f32_16x16x32_bf16 v[180:183], a[232:235], v[112:115], v[180:183]
  ds_read_b64_tr_b16 a[254:255], v28 offset:6144
  v_cvt_pk_bf16_f32 v68, v68, v69
  v_mfma_f32_16x16x32_bf16 v[180:183], a[248:251], v[136:139], v[180:183]
  v_add_f32 v50, v50, v70
  v_add_f32 v50, v50, v71
  v_mfma_f32_16x16x32_bf16 v[196:199], a[232:235], v[116:119], v[196:199]
  v_cvt_pk_bf16_f32 v69, v70, v71
  v_fma_f32 v83, v83, s94, v59
  ds_write_b64 v33, v[68:69] offset:2048
  v_mfma_f32_16x16x32_bf16 v[196:199], a[248:251], v[140:143], v[196:199]
  s_waitcnt vmcnt(10)
  v_exp_f32 v72, v72
  v_mfma_f32_16x16x32_bf16 v[212:215], a[232:235], v[120:123], v[212:215]
  buffer_load_dwordx4 v4, s[12:15], s6 offen offset:2048 nt lds
  v_lshrrev_b32 v43, 3, v1
  v_mfma_f32_16x16x32_bf16 v[212:215], a[248:251], v[144:147], v[212:215]
  v_exp_f32 v73, v73
  v_mfma_f32_16x16x32_bf16 v[228:231], a[232:235], v[124:127], v[228:231]
  v_exp_f32 v74, v74
  v_mfma_f32_16x16x32_bf16 v[228:231], a[248:251], v[148:151], v[228:231]
  v_exp_f32 v75, v75
  v_mfma_f32_16x16x32_bf16 v[244:247], a[232:235], v[128:131], v[244:247]
  ds_read_b128 a[192:195], v21 offset:32768
  v_add_f32 v51, v51, v72
  v_mfma_f32_16x16x32_bf16 v[244:247], a[248:251], v[152:155], v[244:247]
  ds_read_b128 a[196:199], v22 offset:32768
  v_add_f32 v51, v51, v73
  s_waitcnt lgkmcnt(5)
  v_mfma_f32_16x16x32_bf16 v[168:171], a[236:239], v[108:111], v[168:171]
  buffer_load_dwordx4 v5, s[12:15], s6 offen offset:3072 nt lds
  v_cvt_pk_bf16_f32 v72, v72, v73
  s_waitcnt lgkmcnt(3)
  v_mfma_f32_16x16x32_bf16 v[168:171], a[252:255], v[132:135], v[168:171]
  ds_read_b128 a[200:203], v23 offset:32768
  v_add_f32 v51, v51, v74
  v_mfma_f32_16x16x32_bf16 v[184:187], a[236:239], v[112:115], v[184:187]
  ds_read_b128 a[204:207], v24 offset:32768
  v_add_f32 v51, v51, v75
  v_mfma_f32_16x16x32_bf16 v[184:187], a[252:255], v[136:139], v[184:187]
  ds_read_b128 a[208:211], v21 offset:33024
  s_add_u32 m0, s64, 4096
  v_mfma_f32_16x16x32_bf16 v[200:203], a[236:239], v[116:119], v[200:203]
  ds_read_b128 a[212:215], v22 offset:33024
  v_cvt_pk_bf16_f32 v73, v74, v75
  ds_write_b64 v33, v[72:73] offset:3072
  v_mfma_f32_16x16x32_bf16 v[200:203], a[252:255], v[140:143], v[200:203]
  ds_read_b128 a[216:219], v23 offset:33024
  v_and_b32 v44, 7, v1
  v_mfma_f32_16x16x32_bf16 v[216:219], a[236:239], v[120:123], v[216:219]
  buffer_load_dwordx4 v6, s[12:15], s6 offen nt lds
  v_mul_u32_u24 v45, 896, v43
  v_mfma_f32_16x16x32_bf16 v[216:219], a[252:255], v[144:147], v[216:219]
  ds_read_b128 a[220:223], v24 offset:33024
  v_lshl_add_u32 v45, v44, 4, v45
  v_mfma_f32_16x16x32_bf16 v[232:235], a[236:239], v[124:127], v[232:235]
  v_exp_f32 v76, v76
  v_mfma_f32_16x16x32_bf16 v[232:235], a[252:255], v[148:151], v[232:235]
  v_exp_f32 v77, v77
  v_mfma_f32_16x16x32_bf16 v[248:251], a[236:239], v[128:131], v[248:251]
  v_exp_f32 v78, v78
  v_mfma_f32_16x16x32_bf16 v[248:251], a[252:255], v[152:155], v[248:251]
  v_exp_f32 v79, v79
  s_waitcnt lgkmcnt(8)
  v_mfma_f32_16x16x32_bf16 v[60:63], a[192:195], a[0:3], 0
  buffer_load_dwordx4 v7, s[12:15], s6 offen offset:1024 nt lds
  v_add_f32 v52, v52, v76
  s_waitcnt lgkmcnt(7)
  v_mfma_f32_16x16x32_bf16 v[60:63], a[196:199], a[24:27], v[60:63]
  v_add_f32 v52, v52, v77
  v_cvt_pk_bf16_f32 v76, v76, v77
  s_waitcnt lgkmcnt(6)
  v_mfma_f32_16x16x32_bf16 v[60:63], a[200:203], a[48:51], v[60:63]
  v_add_f32 v52, v52, v78
  v_add_f32 v52, v52, v79
  s_waitcnt lgkmcnt(5)
  v_mfma_f32_16x16x32_bf16 v[60:63], a[204:207], a[72:75], v[60:63]
  v_cvt_pk_bf16_f32 v77, v78, v79
  v_add_u32 v101, s81, v45
  s_waitcnt lgkmcnt(4)
  v_mfma_f32_16x16x32_bf16 v[60:63], a[208:211], a[96:99], v[60:63]
  ds_write_b64 v33, v[76:77] offset:4096
  s_waitcnt lgkmcnt(4)
  v_mfma_f32_16x16x32_bf16 v[60:63], a[212:215], a[120:123], v[60:63]
  s_mul_i32 s82, s82, 6144
  v_exp_f32 v80, v80
  s_waitcnt lgkmcnt(2)
  v_mfma_f32_16x16x32_bf16 v[60:63], a[216:219], a[144:147], v[60:63]
  buffer_load_dwordx4 v8, s[12:15], s6 offen offset:2048 nt lds
  s_lshr_b32 s3, s95, 1
  s_waitcnt lgkmcnt(1)
  v_mfma_f32_16x16x32_bf16 v[60:63], a[220:223], a[168:171], v[60:63]
  s_lshl_b32 s3, s3, 10
  v_exp_f32 v81, v81
  v_mfma_f32_16x16x32_bf16 v[64:67], a[192:195], a[4:7], 0
  s_add_u32 s82, s82, s3
  v_exp_f32 v82, v82
  v_mfma_f32_16x16x32_bf16 v[64:67], a[196:199], a[28:31], v[64:67]
  s_and_b32 s95, s95, 1
  v_exp_f32 v83, v83
  v_mfma_f32_16x16x32_bf16 v[64:67], a[200:203], a[52:55], v[64:67]
  s_lshl_b32 s95, s95, 7
  v_add_f32 v53, v53, v80
  v_add_f32 v53, v53, v81
  v_mfma_f32_16x16x32_bf16 v[64:67], a[204:207], a[76:79], v[64:67]
  s_add_u32 s82, s82, s95
  v_cvt_pk_bf16_f32 v80, v80, v81
  v_add_f32 v53, v53, v82
  v_mfma_f32_16x16x32_bf16 v[64:67], a[208:211], a[100:103], v[64:67]
  buffer_load_dwordx4 v9, s[12:15], s6 offen offset:3072 nt lds
  v_add_f32 v53, v53, v83
  v_mfma_f32_16x16x32_bf16 v[64:67], a[212:215], a[124:127], v[64:67]
  v_cvt_pk_bf16_f32 v81, v82, v83
  v_lshrrev_b32 v45, 5, v1
  v_mfma_f32_16x16x32_bf16 v[64:67], a[216:219], a[148:151], v[64:67]
  ds_write_b64 v33, v[80:81] offset:5120
  v_mfma_f32_16x16x32_bf16 v[64:67], a[220:223], a[172:175], v[64:67]
  v_and_b32 v43, 3, v43
  v_mul_u32_u24 v46, 3072, v45
  v_mfma_f32_16x16x32_bf16 v[68:71], a[192:195], a[8:11], 0
  s_add_u32 m0, s65, 0
  s_xor_b32 s6, s63, 139264
  v_lshl_add_u32 v46, v43, 8, v46
  v_mfma_f32_16x16x32_bf16 v[68:71], a[196:199], a[32:35], v[68:71]
  v_lshl_add_u32 v46, v44, 4, v46
  v_add_u32 v100, s82, v46
  v_mfma_f32_16x16x32_bf16 v[68:71], a[200:203], a[56:59], v[68:71]
  v_lshlrev_b32 v44, 7, v44
  v_lshl_add_u32 v44, v45, 6, v44
  v_mfma_f32_16x16x32_bf16 v[68:71], a[204:207], a[80:83], v[68:71]
  s_waitcnt lgkmcnt(0)
  s_barrier
  buffer_load_dwordx4 v10, s[16:19], s6 offen nt lds
  v_lshl_add_u32 v44, v43, 3, v44
  v_mfma_f32_16x16x32_bf16 v[68:71], a[208:211], a[104:107], v[68:71]
  ds_read_b128 v[108:111], v34
  v_fma_f32 v60, v60, s94, v54
  v_mfma_f32_16x16x32_bf16 v[68:71], a[212:215], a[128:131], v[68:71]
  ds_read_b128 v[132:135], v34 offset:6144
  v_fma_f32 v61, v61, s94, v54
  v_mfma_f32_16x16x32_bf16 v[68:71], a[216:219], a[152:155], v[68:71]
  v_fma_f32 v62, v62, s94, v54
  v_fma_f32 v63, v63, s94, v54
  v_mfma_f32_16x16x32_bf16 v[68:71], a[220:223], a[176:179], v[68:71]
  v_exp_f32 v60, v60
  v_mfma_f32_16x16x32_bf16 v[72:75], a[192:195], a[12:15], 0
  ds_read_b128 v[112:115], v34 offset:1024
  v_fma_f32 v64, v64, s94, v55
  v_mfma_f32_16x16x32_bf16 v[72:75], a[196:199], a[36:39], v[72:75]
  buffer_load_dwordx4 v11, s[16:19], s6 offen offset:1024 nt lds
  v_fma_f32 v65, v65, s94, v55
  v_mfma_f32_16x16x32_bf16 v[72:75], a[200:203], a[60:63], v[72:75]
  ds_read_b128 v[136:139], v34 offset:7168
  v_fma_f32 v66, v66, s94, v55
  v_mfma_f32_16x16x32_bf16 v[72:75], a[204:207], a[84:87], v[72:75]
  v_exp_f32 v61, v61
  v_mfma_f32_16x16x32_bf16 v[72:75], a[208:211], a[108:111], v[72:75]
  s_waitcnt vmcnt(14)
  ds_read_b64_tr_b16 a[224:225], v25 offset:8192
  v_fma_f32 v67, v67, s94, v55
  v_mfma_f32_16x16x32_bf16 v[72:75], a[212:215], a[132:135], v[72:75]
  ds_read_b128 v[116:119], v34 offset:2048
  v_fma_f32 v68, v68, s94, v56
  v_mfma_f32_16x16x32_bf16 v[72:75], a[216:219], a[156:159], v[72:75]
  ds_read_b64_tr_b16 a[226:227], v25 offset:10240
  v_fma_f32 v69, v69, s94, v56
  v_mfma_f32_16x16x32_bf16 v[72:75], a[220:223], a[180:183], v[72:75]
  buffer_load_dwordx4 v12, s[16:19], s6 offen offset:2048 nt lds
  v_fma_f32 v70, v70, s94, v56
  v_mfma_f32_16x16x32_bf16 v[76:79], a[192:195], a[16:19], 0
  ds_read_b128 v[140:143], v34 offset:8192
  v_fma_f32 v71, v71, s94, v56
  v_mfma_f32_16x16x32_bf16 v[76:79], a[196:199], a[40:43], v[76:79]
  v_exp_f32 v62, v62
  v_mfma_f32_16x16x32_bf16 v[76:79], a[200:203], a[64:67], v[76:79]
  s_waitcnt vmcnt(11)
  ds_read_b128 v[120:123], v34 offset:3072
  v_add_u32 v102, s64, v44
  v_mfma_f32_16x16x32_bf16 v[76:79], a[204:207], a[88:91], v[76:79]
  ds_read_b64_tr_b16 a[240:241], v25 offset:12288
  v_add_u32 v103, s64, v35
  v_mfma_f32_16x16x32_bf16 v[76:79], a[208:211], a[112:115], v[76:79]
  ds_read_b128 v[144:147], v34 offset:9216
  v_fma_f32 v72, v72, s94, v57
  v_mfma_f32_16x16x32_bf16 v[76:79], a[212:215], a[136:139], v[76:79]
  buffer_load_dwordx4 v13, s[16:19], s6 offen offset:3072 nt lds
  v_fma_f32 v73, v73, s94, v57
  v_mfma_f32_16x16x32_bf16 v[76:79], a[216:219], a[160:163], v[76:79]
  ds_read_b64_tr_b16 a[242:243], v25 offset:14336
  v_fma_f32 v74, v74, s94, v57
  v_mfma_f32_16x16x32_bf16 v[76:79], a[220:223], a[184:187], v[76:79]
  ds_read_b128 v[124:127], v34 offset:4096
  v_fma_f32 v75, v75, s94, v57
  v_mfma_f32_16x16x32_bf16 v[80:83], a[192:195], a[20:23], 0
  ds_read_b64_tr_b16 a[228:229], v26 offset:8192
  s_add_u32 m0, s65, 4096
  v_mfma_f32_16x16x32_bf16 v[80:83], a[196:199], a[44:47], v[80:83]
  ds_read_b128 v[148:151], v34 offset:10240
  s_xor_b32 s6, s63, 172032
  v_mfma_f32_16x16x32_bf16 v[80:83], a[200:203], a[68:71], v[80:83]
  ds_read_b64_tr_b16 a[230:231], v26 offset:10240
  v_mfma_f32_16x16x32_bf16 v[80:83], a[204:207], a[92:95], v[80:83]
  buffer_load_dwordx4 v10, s[16:19], s6 offen nt lds
  v_mfma_f32_16x16x32_bf16 v[80:83], a[208:211], a[116:119], v[80:83]
  ds_read_b128 v[128:131], v34 offset:5120
  v_fma_f32 v76, v76, s94, v58
  v_mfma_f32_16x16x32_bf16 v[80:83], a[212:215], a[140:143], v[80:83]
  v_exp_f32 v63, v63
  v_mfma_f32_16x16x32_bf16 v[80:83], a[216:219], a[164:167], v[80:83]
  ds_read_b128 v[152:155], v34 offset:11264
  v_add_f32 v48, v48, v60
  v_mfma_f32_16x16x32_bf16 v[80:83], a[220:223], a[188:191], v[80:83]
  ds_read_b64_tr_b16 a[244:245], v26 offset:12288
  v_add_f32 v48, v48, v61
  s_waitcnt lgkmcnt(12)
  v_mfma_f32_16x16x32_bf16 v[156:159], a[224:227], v[108:111], v[156:159]
  ds_read_b64_tr_b16 a[246:247], v26 offset:14336
  v_cvt_pk_bf16_f32 v60, v60, v61
  s_waitcnt lgkmcnt(8)
  v_mfma_f32_16x16x32_bf16 v[156:159], a[240:243], v[132:135], v[156:159]
  buffer_load_dwordx4 v11, s[16:19], s6 offen offset:1024 nt lds
  v_add_f32 v48, v48, v62
  v_mfma_f32_16x16x32_bf16 v[172:175], a[224:227], v[112:115], v[172:175]
  v_add_f32 v48, v48, v63
  v_cvt_pk_bf16_f32 v61, v62, v63
  v_mfma_f32_16x16x32_bf16 v[172:175], a[240:243], v[136:139], v[172:175]
  ds_write_b64 v33, v[60:61] offset:12288
  v_mfma_f32_16x16x32_bf16 v[188:191], a[224:227], v[116:119], v[188:191]
  ds_read_b64_tr_b16 a[232:233], v27 offset:8192
  v_fma_f32 v77, v77, s94, v58
  v_mfma_f32_16x16x32_bf16 v[188:191], a[240:243], v[140:143], v[188:191]
  v_exp_f32 v64, v64
  v_mfma_f32_16x16x32_bf16 v[204:207], a[224:227], v[120:123], v[204:207]
  ds_read_b64_tr_b16 a[234:235], v27 offset:10240
  v_fma_f32 v78, v78, s94, v58
  v_mfma_f32_16x16x32_bf16 v[204:207], a[240:243], v[144:147], v[204:207]
  buffer_load_dwordx4 v12, s[16:19], s6 offen offset:2048 nt lds
  v_fma_f32 v79, v79, s94, v58
  s_waitcnt lgkmcnt(10)
  v_mfma_f32_16x16x32_bf16 v[220:223], a[224:227], v[124:127], v[220:223]
  v_exp_f32 v65, v65
  s_waitcnt lgkmcnt(8)
  v_mfma_f32_16x16x32_bf16 v[220:223], a[240:243], v[148:151], v[220:223]
  v_exp_f32 v66, v66
  s_waitcnt lgkmcnt(6)
  v_mfma_f32_16x16x32_bf16 v[236:239], a[224:227], v[128:131], v[236:239]
  v_exp_f32 v67, v67
  s_waitcnt lgkmcnt(5)
  v_mfma_f32_16x16x32_bf16 v[236:239], a[240:243], v[152:155], v[236:239]
  ds_read_b64_tr_b16 a[248:249], v27 offset:12288
  v_add_f32 v49, v49, v64
  v_mfma_f32_16x16x32_bf16 v[160:163], a[228:231], v[108:111], v[160:163]
  ds_read_b64_tr_b16 a[250:251], v27 offset:14336
  v_add_f32 v49, v49, v65
  s_waitcnt lgkmcnt(5)
  v_mfma_f32_16x16x32_bf16 v[160:163], a[244:247], v[132:135], v[160:163]
  buffer_load_dwordx4 v13, s[16:19], s6 offen offset:3072 nt lds
  v_cvt_pk_bf16_f32 v64, v64, v65
  v_mfma_f32_16x16x32_bf16 v[176:179], a[228:231], v[112:115], v[176:179]
  v_add_f32 v49, v49, v66
  v_add_f32 v49, v49, v67
  v_mfma_f32_16x16x32_bf16 v[176:179], a[244:247], v[136:139], v[176:179]
  v_cvt_pk_bf16_f32 v65, v66, v67
  v_fma_f32 v80, v80, s94, v59
  v_mfma_f32_16x16x32_bf16 v[192:195], a[228:231], v[116:119], v[192:195]
  ds_write_b64 v33, v[64:65] offset:13312
  v_mfma_f32_16x16x32_bf16 v[192:195], a[244:247], v[140:143], v[192:195]
  ds_read_b64_tr_b16 a[236:237], v28 offset:8192
  s_add_u32 m0, s64, 32768
  v_mfma_f32_16x16x32_bf16 v[208:211], a[228:231], v[120:123], v[208:211]
  ds_read_b64_tr_b16 a[238:239], v28 offset:10240
  s_xor_b32 s6, s62, 204800
  v_mfma_f32_16x16x32_bf16 v[208:211], a[244:247], v[144:147], v[208:211]
  v_exp_f32 v68, v68
  v_mfma_f32_16x16x32_bf16 v[224:227], a[228:231], v[124:127], v[224:227]
  buffer_load_dwordx4 v2, s[12:15], s6 offen nt lds
  v_fma_f32 v81, v81, s94, v59
  v_mfma_f32_16x16x32_bf16 v[224:227], a[244:247], v[148:151], v[224:227]
  v_exp_f32 v69, v69
  v_mfma_f32_16x16x32_bf16 v[240:243], a[228:231], v[128:131], v[240:243]
  v_exp_f32 v70, v70
  v_mfma_f32_16x16x32_bf16 v[240:243], a[244:247], v[152:155], v[240:243]
  v_exp_f32 v71, v71
  s_waitcnt lgkmcnt(5)
  v_mfma_f32_16x16x32_bf16 v[164:167], a[232:235], v[108:111], v[164:167]
  ds_read_b64_tr_b16 a[252:253], v28 offset:12288
  v_add_f32 v50, v50, v68
  s_waitcnt lgkmcnt(4)
  v_mfma_f32_16x16x32_bf16 v[164:167], a[248:251], v[132:135], v[164:167]
  ds_read_b64_tr_b16 a[254:255], v28 offset:14336
  v_add_f32 v50, v50, v69
  v_mfma_f32_16x16x32_bf16 v[180:183], a[232:235], v[112:115], v[180:183]
  buffer_load_dwordx4 v3, s[12:15], s6 offen offset:1024 nt lds
  v_cvt_pk_bf16_f32 v68, v68, v69
  v_mfma_f32_16x16x32_bf16 v[180:183], a[248:251], v[136:139], v[180:183]
  v_add_f32 v50, v50, v70
  v_add_f32 v50, v50, v71
  v_mfma_f32_16x16x32_bf16 v[196:199], a[232:235], v[116:119], v[196:199]
  v_cvt_pk_bf16_f32 v69, v70, v71
  v_fma_f32 v82, v82, s94, v59
  ds_write_b64 v33, v[68:69] offset:14336
  v_mfma_f32_16x16x32_bf16 v[196:199], a[248:251], v[140:143], v[196:199]
  s_waitcnt vmcnt(10)
  v_exp_f32 v72, v72
  v_mfma_f32_16x16x32_bf16 v[212:215], a[232:235], v[120:123], v[212:215]
  v_exp_f32 v73, v73
  v_mfma_f32_16x16x32_bf16 v[212:215], a[248:251], v[144:147], v[212:215]
  v_exp_f32 v74, v74
  v_mfma_f32_16x16x32_bf16 v[228:231], a[232:235], v[124:127], v[228:231]
  buffer_load_dwordx4 v4, s[12:15], s6 offen offset:2048 nt lds
  v_fma_f32 v83, v83, s94, v59
  v_mfma_f32_16x16x32_bf16 v[228:231], a[248:251], v[148:151], v[228:231]
  v_exp_f32 v75, v75
  v_mfma_f32_16x16x32_bf16 v[244:247], a[232:235], v[128:131], v[244:247]
  ds_read_b128 a[192:195], v21
  v_add_f32 v51, v51, v72
  v_mfma_f32_16x16x32_bf16 v[244:247], a[248:251], v[152:155], v[244:247]
  ds_read_b128 a[196:199], v22
  v_add_f32 v51, v51, v73
  s_waitcnt lgkmcnt(5)
  v_mfma_f32_16x16x32_bf16 v[168:171], a[236:239], v[108:111], v[168:171]
  ds_read_b128 a[200:203], v23
  v_cvt_pk_bf16_f32 v72, v72, v73
  s_waitcnt lgkmcnt(4)
  v_mfma_f32_16x16x32_bf16 v[168:171], a[252:255], v[132:135], v[168:171]
  ds_read_b128 a[204:207], v24
  v_add_f32 v51, v51, v74
  v_mfma_f32_16x16x32_bf16 v[184:187], a[236:239], v[112:115], v[184:187]
  buffer_load_dwordx4 v5, s[12:15], s6 offen offset:3072 nt lds
  v_add_f32 v51, v51, v75
  v_mfma_f32_16x16x32_bf16 v[184:187], a[252:255], v[136:139], v[184:187]
  ds_read_b128 a[208:211], v21 offset:256
  v_cvt_pk_bf16_f32 v73, v74, v75
  v_mfma_f32_16x16x32_bf16 v[200:203], a[236:239], v[116:119], v[200:203]
  ds_write_b64 v33, v[72:73] offset:15360
  v_mfma_f32_16x16x32_bf16 v[200:203], a[252:255], v[140:143], v[200:203]
  ds_read_b128 a[212:215], v22 offset:256
  s_add_u32 m0, s64, 36864
  v_mfma_f32_16x16x32_bf16 v[216:219], a[236:239], v[120:123], v[216:219]
  ds_read_b128 a[216:219], v23 offset:256
  v_mfma_f32_16x16x32_bf16 v[216:219], a[252:255], v[144:147], v[216:219]
  ds_read_b128 a[220:223], v24 offset:256
  v_mfma_f32_16x16x32_bf16 v[232:235], a[236:239], v[124:127], v[232:235]
  buffer_load_dwordx4 v6, s[12:15], s6 offen nt lds
  v_mfma_f32_16x16x32_bf16 v[232:235], a[252:255], v[148:151], v[232:235]
  v_exp_f32 v76, v76
  v_mfma_f32_16x16x32_bf16 v[248:251], a[236:239], v[128:131], v[248:251]
  v_exp_f32 v77, v77
  v_mfma_f32_16x16x32_bf16 v[248:251], a[252:255], v[152:155], v[248:251]
  v_exp_f32 v78, v78
  s_waitcnt lgkmcnt(8)
  v_mfma_f32_16x16x32_bf16 v[60:63], a[192:195], a[0:3], 0
  v_exp_f32 v79, v79
  s_waitcnt lgkmcnt(7)
  v_mfma_f32_16x16x32_bf16 v[60:63], a[196:199], a[24:27], v[60:63]
  v_add_f32 v52, v52, v76
  v_add_f32 v52, v52, v77
  s_waitcnt lgkmcnt(6)
  v_mfma_f32_16x16x32_bf16 v[60:63], a[200:203], a[48:51], v[60:63]
  buffer_load_dwordx4 v7, s[12:15], s6 offen offset:1024 nt lds
  v_cvt_pk_bf16_f32 v76, v76, v77
  s_waitcnt lgkmcnt(5)
  v_mfma_f32_16x16x32_bf16 v[60:63], a[204:207], a[72:75], v[60:63]
  v_add_f32 v52, v52, v78
  v_add_f32 v52, v52, v79
  s_waitcnt lgkmcnt(4)
  v_mfma_f32_16x16x32_bf16 v[60:63], a[208:211], a[96:99], v[60:63]
  v_cvt_pk_bf16_f32 v77, v78, v79
  ds_write_b64 v33, v[76:77] offset:16384
  s_waitcnt lgkmcnt(3)
  v_mfma_f32_16x16x32_bf16 v[60:63], a[212:215], a[120:123], v[60:63]
  v_exp_f32 v80, v80
  s_waitcnt lgkmcnt(2)
  v_mfma_f32_16x16x32_bf16 v[60:63], a[216:219], a[144:147], v[60:63]
  v_exp_f32 v81, v81
  s_waitcnt lgkmcnt(1)
  v_mfma_f32_16x16x32_bf16 v[60:63], a[220:223], a[168:171], v[60:63]
  v_exp_f32 v82, v82
  v_mfma_f32_16x16x32_bf16 v[64:67], a[192:195], a[4:7], 0
  buffer_load_dwordx4 v8, s[12:15], s6 offen offset:2048 nt lds
  v_mfma_f32_16x16x32_bf16 v[64:67], a[196:199], a[28:31], v[64:67]
  v_exp_f32 v83, v83
  v_mfma_f32_16x16x32_bf16 v[64:67], a[200:203], a[52:55], v[64:67]
  v_add_f32 v53, v53, v80
  v_add_f32 v53, v53, v81
  v_mfma_f32_16x16x32_bf16 v[64:67], a[204:207], a[76:79], v[64:67]
  v_cvt_pk_bf16_f32 v80, v80, v81
  v_add_f32 v53, v53, v82
  v_mfma_f32_16x16x32_bf16 v[64:67], a[208:211], a[100:103], v[64:67]
  s_lshl_b32 s82, s58, 2
  v_add_f32 v53, v53, v83
  v_cvt_pk_bf16_f32 v81, v82, v83
  v_mfma_f32_16x16x32_bf16 v[64:67], a[212:215], a[124:127], v[64:67]
  ds_write_b64 v33, v[80:81] offset:17408
  v_mfma_f32_16x16x32_bf16 v[64:67], a[216:219], a[148:151], v[64:67]
  buffer_load_dwordx4 v9, s[12:15], s6 offen offset:3072 nt lds
  v_mov_b32 v44, 0
  v_mfma_f32_16x16x32_bf16 v[64:67], a[220:223], a[172:175], v[64:67]
  v_mfma_f32_16x16x32_bf16 v[68:71], a[192:195], a[8:11], 0
  buffer_load_dword v39, v44, s[36:39], s82 offen sc1
  v_mfma_f32_16x16x32_bf16 v[68:71], a[196:199], a[32:35], v[68:71]
  v_mfma_f32_16x16x32_bf16 v[68:71], a[200:203], a[56:59], v[68:71]
  s_add_u32 m0, s65, 8192
  s_xor_b32 s6, s63, 196608
  v_mfma_f32_16x16x32_bf16 v[68:71], a[204:207], a[80:83], v[68:71]
  s_waitcnt lgkmcnt(0)
  s_barrier
  ds_read_b128 v[108:111], v34 offset:12288
  v_mfma_f32_16x16x32_bf16 v[68:71], a[208:211], a[104:107], v[68:71]
  v_fma_f32 v60, v60, s94, v54
  v_fma_f32 v61, v61, s94, v54
  v_mfma_f32_16x16x32_bf16 v[68:71], a[212:215], a[128:131], v[68:71]
  buffer_load_dwordx4 v10, s[16:19], s6 offen nt lds
  v_fma_f32 v62, v62, s94, v54
  v_mfma_f32_16x16x32_bf16 v[68:71], a[216:219], a[152:155], v[68:71]
  ds_read_b128 v[132:135], v34 offset:18432
  v_fma_f32 v63, v63, s94, v54
  v_mfma_f32_16x16x32_bf16 v[68:71], a[220:223], a[176:179], v[68:71]
  v_exp_f32 v60, v60
  v_mfma_f32_16x16x32_bf16 v[72:75], a[192:195], a[12:15], 0
  ds_read_b128 v[112:115], v34 offset:13312
  v_fma_f32 v64, v64, s94, v55
  v_mfma_f32_16x16x32_bf16 v[72:75], a[196:199], a[36:39], v[72:75]
  v_exp_f32 v61, v61
  v_mfma_f32_16x16x32_bf16 v[72:75], a[200:203], a[60:63], v[72:75]
  ds_read_b128 v[136:139], v34 offset:19456
  v_fma_f32 v65, v65, s94, v55
  v_mfma_f32_16x16x32_bf16 v[72:75], a[204:207], a[84:87], v[72:75]
  v_exp_f32 v62, v62
  v_mfma_f32_16x16x32_bf16 v[72:75], a[208:211], a[108:111], v[72:75]
  s_waitcnt vmcnt(14)
  buffer_load_dwordx4 v11, s[16:19], s6 offen offset:1024 nt lds
  v_fma_f32 v66, v66, s94, v55
  v_mfma_f32_16x16x32_bf16 v[72:75], a[212:215], a[132:135], v[72:75]
  ds_read_b64_tr_b16 a[224:225], v25
  v_fma_f32 v67, v67, s94, v55
  v_mfma_f32_16x16x32_bf16 v[72:75], a[216:219], a[156:159], v[72:75]
  ds_read_b64_tr_b16 a[226:227], v25 offset:2048
  v_fma_f32 v68, v68, s94, v56
  v_mfma_f32_16x16x32_bf16 v[72:75], a[220:223], a[180:183], v[72:75]
  ds_read_b128 v[116:119], v34 offset:14336
  v_fma_f32 v69, v69, s94, v56
  v_mfma_f32_16x16x32_bf16 v[76:79], a[192:195], a[16:19], 0
L_it4:
  s_cbranch_execz L_it8
  ds_read_b128 v[140:143], v34 offset:20480
  v_fma_f32 v70, v70, s94, v56
  v_mfma_f32_16x16x32_bf16 v[76:79], a[196:199], a[40:43], v[76:79]
  v_exp_f32 v63, v63
  v_mfma_f32_16x16x32_bf16 v[76:79], a[200:203], a[64:67], v[76:79]
  s_waitcnt vmcnt(11)
  ds_read_b128 v[120:123], v34 offset:15360
  v_add_f32 v48, v48, v60
  v_mfma_f32_16x16x32_bf16 v[76:79], a[204:207], a[88:91], v[76:79]
  buffer_load_dwordx4 v12, s[16:19], s6 offen offset:2048 nt lds
  v_add_f32 v48, v48, v61
  v_mfma_f32_16x16x32_bf16 v[76:79], a[208:211], a[112:115], v[76:79]
  ds_read_b64_tr_b16 a[240:241], v25 offset:4096
  v_cvt_pk_bf16_f32 v60, v60, v61
  v_mfma_f32_16x16x32_bf16 v[76:79], a[212:215], a[136:139], v[76:79]
  ds_read_b128 v[144:147], v34 offset:21504
  v_add_f32 v48, v48, v62
  v_mfma_f32_16x16x32_bf16 v[76:79], a[216:219], a[160:163], v[76:79]
  ds_read_b64_tr_b16 a[242:243], v25 offset:6144
  v_add_f32 v48, v48, v63
  v_mfma_f32_16x16x32_bf16 v[76:79], a[220:223], a[184:187], v[76:79]
  ds_read_b128 v[124:127], v34 offset:16384
  v_cvt_pk_bf16_f32 v61, v62, v63
  v_mfma_f32_16x16x32_bf16 v[80:83], a[192:195], a[20:23], 0
  ds_read_b64_tr_b16 a[228:229], v26
  v_fma_f32 v71, v71, s94, v56
  v_mfma_f32_16x16x32_bf16 v[80:83], a[196:199], a[44:47], v[80:83]
  ds_read_b128 v[148:151], v34 offset:22528
  v_fma_f32 v72, v72, s94, v57
  v_mfma_f32_16x16x32_bf16 v[80:83], a[200:203], a[68:71], v[80:83]
  buffer_load_dwordx4 v13, s[16:19], s6 offen offset:3072 nt lds
  v_fma_f32 v73, v73, s94, v57
  v_mfma_f32_16x16x32_bf16 v[80:83], a[204:207], a[92:95], v[80:83]
  ds_read_b64_tr_b16 a[230:231], v26 offset:2048
  v_fma_f32 v74, v74, s94, v57
  v_mfma_f32_16x16x32_bf16 v[80:83], a[208:211], a[116:119], v[80:83]
  ds_read_b128 v[128:131], v34 offset:17408
  v_fma_f32 v75, v75, s94, v57
  v_mfma_f32_16x16x32_bf16 v[80:83], a[212:215], a[140:143], v[80:83]
  ds_write_b64 v33, v[60:61]
  v_mfma_f32_16x16x32_bf16 v[80:83], a[216:219], a[164:167], v[80:83]
  ds_read_b128 v[152:155], v34 offset:23552
  v_fma_f32 v76, v76, s94, v58
  v_mfma_f32_16x16x32_bf16 v[80:83], a[220:223], a[188:191], v[80:83]
  ds_read_b64_tr_b16 a[244:245], v26 offset:4096
  s_add_u32 m0, s65, 12288
  s_waitcnt lgkmcnt(14)
  v_mfma_f32_16x16x32_bf16 v[156:159], a[224:227], v[108:111], v[156:159]
  ds_read_b64_tr_b16 a[246:247], v26 offset:6144
  s_xor_b32 s6, s63, 229376
  s_waitcnt lgkmcnt(9)
  v_mfma_f32_16x16x32_bf16 v[156:159], a[240:243], v[132:135], v[156:159]
  v_exp_f32 v64, v64
  v_mfma_f32_16x16x32_bf16 v[172:175], a[224:227], v[112:115], v[172:175]
  buffer_load_dwordx4 v10, s[16:19], s6 offen nt lds
  v_fma_f32 v77, v77, s94, v58
  v_mfma_f32_16x16x32_bf16 v[172:175], a[240:243], v[136:139], v[172:175]
  v_exp_f32 v65, v65
  v_mfma_f32_16x16x32_bf16 v[188:191], a[224:227], v[116:119], v[188:191]
  ds_read_b64_tr_b16 a[232:233], v27
  v_fma_f32 v78, v78, s94, v58
  v_mfma_f32_16x16x32_bf16 v[188:191], a[240:243], v[140:143], v[188:191]
  v_exp_f32 v66, v66
  v_mfma_f32_16x16x32_bf16 v[204:207], a[224:227], v[120:123], v[204:207]
  ds_read_b64_tr_b16 a[234:235], v27 offset:2048
  v_fma_f32 v79, v79, s94, v58
  v_mfma_f32_16x16x32_bf16 v[204:207], a[240:243], v[144:147], v[204:207]
  v_exp_f32 v67, v67
  s_waitcnt lgkmcnt(10)
  v_mfma_f32_16x16x32_bf16 v[220:223], a[224:227], v[124:127], v[220:223]
  v_add_f32 v49, v49, v64
  v_add_f32 v49, v49, v65
  s_waitcnt lgkmcnt(8)
  v_mfma_f32_16x16x32_bf16 v[220:223], a[240:243], v[148:151], v[220:223]
  buffer_load_dwordx4 v11, s[16:19], s6 offen offset:1024 nt lds
  v_cvt_pk_bf16_f32 v64, v64, v65
  s_waitcnt lgkmcnt(6)
  v_mfma_f32_16x16x32_bf16 v[236:239], a[224:227], v[128:131], v[236:239]
  ds_read_b64_tr_b16 a[248:249], v27 offset:4096
  v_add_f32 v49, v49, v66
  s_waitcnt lgkmcnt(5)
  v_mfma_f32_16x16x32_bf16 v[236:239], a[240:243], v[152:155], v[236:239]
  v_add_f32 v49, v49, v67
  v_cvt_pk_bf16_f32 v65, v66, v67
  v_mfma_f32_16x16x32_bf16 v[160:163], a[228:231], v[108:111], v[160:163]
  ds_write_b64 v33, v[64:65] offset:1024
  s_waitcnt lgkmcnt(4)
  v_mfma_f32_16x16x32_bf16 v[160:163], a[244:247], v[132:135], v[160:163]
  ds_read_b64_tr_b16 a[250:251], v27 offset:6144
  v_fma_f32 v80, v80, s94, v59
  v_mfma_f32_16x16x32_bf16 v[176:179], a[228:231], v[112:115], v[176:179]
  v_exp_f32 v68, v68
  v_mfma_f32_16x16x32_bf16 v[176:179], a[244:247], v[136:139], v[176:179]
  v_exp_f32 v69, v69
  v_mfma_f32_16x16x32_bf16 v[192:195], a[228:231], v[116:119], v[192:195]
  buffer_load_dwordx4 v12, s[16:19], s6 offen offset:2048 nt lds
  v_fma_f32 v81, v81, s94, v59
  v_mfma_f32_16x16x32_bf16 v[192:195], a[244:247], v[140:143], v[192:195]
  ds_read_b64_tr_b16 a[236:237], v28
  v_fma_f32 v82, v82, s94, v59
  v_mfma_f32_16x16x32_bf16 v[208:211], a[228:231], v[120:123], v[208:211]
  ds_read_b64_tr_b16 a[238:239], v28 offset:2048
  v_fma_f32 v83, v83, s94, v59
  v_mfma_f32_16x16x32_bf16 v[208:211], a[244:247], v[144:147], v[208:211]
  v_exp_f32 v70, v70
  v_mfma_f32_16x16x32_bf16 v[224:227], a[228:231], v[124:127], v[224:227]
  v_exp_f32 v71, v71
  v_mfma_f32_16x16x32_bf16 v[224:227], a[244:247], v[148:151], v[224:227]
  v_add_f32 v50, v50, v68
  v_add_f32 v50, v50, v69
  v_mfma_f32_16x16x32_bf16 v[240:243], a[228:231], v[128:131], v[240:243]
  ds_read_b64_tr_b16 a[252:253], v28 offset:4096
  v_cvt_pk_bf16_f32 v68, v68, v69
  v_mfma_f32_16x16x32_bf16 v[240:243], a[244:247], v[152:155], v[240:243]
  buffer_load_dwordx4 v13, s[16:19], s6 offen offset:3072 nt lds
  v_add_f32 v50, v50, v70
  s_waitcnt lgkmcnt(6)
  v_mfma_f32_16x16x32_bf16 v[164:167], a[232:235], v[108:111], v[164:167]
  ds_read_b64_tr_b16 a[254:255], v28 offset:6144
  v_add_f32 v50, v50, v71
  s_waitcnt lgkmcnt(4)
  v_mfma_f32_16x16x32_bf16 v[164:167], a[248:251], v[132:135], v[164:167]
  v_cvt_pk_bf16_f32 v69, v70, v71
  v_mfma_f32_16x16x32_bf16 v[180:183], a[232:235], v[112:115], v[180:183]
  ds_write_b64 v33, v[68:69] offset:2048
  v_mfma_f32_16x16x32_bf16 v[180:183], a[248:251], v[136:139], v[180:183]
  v_exp_f32 v72, v72
  v_mfma_f32_16x16x32_bf16 v[196:199], a[232:235], v[116:119], v[196:199]
  s_add_u32 m0, s65, 0
  s_xor_b32 s6, s63, 204800
  v_mfma_f32_16x16x32_bf16 v[196:199], a[248:251], v[140:143], v[196:199]
  s_waitcnt vmcnt(9)
  v_exp_f32 v73, v73
  v_mfma_f32_16x16x32_bf16 v[212:215], a[232:235], v[120:123], v[212:215]
  v_exp_f32 v74, v74
  v_mfma_f32_16x16x32_bf16 v[212:215], a[248:251], v[144:147], v[212:215]
  s_waitcnt lgkmcnt(3)
  buffer_load_dwordx4 v10, s[16:19], s6 offen nt lds
  v_mfma_f32_16x16x32_bf16 v[228:231], a[232:235], v[124:127], v[228:231]
  v_exp_f32 v75, v75
  v_mfma_f32_16x16x32_bf16 v[228:231], a[248:251], v[148:151], v[228:231]
  ds_read_b128 a[192:195], v21 offset:32768
  v_add_f32 v51, v51, v72
  v_mfma_f32_16x16x32_bf16 v[244:247], a[232:235], v[128:131], v[244:247]
  ds_read_b128 a[196:199], v22 offset:32768
  v_add_f32 v51, v51, v73
  v_mfma_f32_16x16x32_bf16 v[244:247], a[248:251], v[152:155], v[244:247]
  ds_read_b128 a[200:203], v23 offset:32768
  v_cvt_pk_bf16_f32 v72, v72, v73
  v_mfma_f32_16x16x32_bf16 v[168:171], a[236:239], v[108:111], v[168:171]
  ds_read_b128 a[204:207], v24 offset:32768
  v_add_f32 v51, v51, v74
  s_waitcnt lgkmcnt(5)
  v_mfma_f32_16x16x32_bf16 v[168:171], a[252:255], v[132:135], v[168:171]
  ds_read_b128 a[208:211], v21 offset:33024
  v_add_f32 v51, v51, v75
  v_mfma_f32_16x16x32_bf16 v[184:187], a[236:239], v[112:115], v[184:187]
  buffer_load_dwordx4 v11, s[16:19], s6 offen offset:1024 nt lds
  v_cvt_pk_bf16_f32 v73, v74, v75
  v_mfma_f32_16x16x32_bf16 v[184:187], a[252:255], v[136:139], v[184:187]
  ds_write_b64 v33, v[72:73] offset:3072
  v_mfma_f32_16x16x32_bf16 v[200:203], a[236:239], v[116:119], v[200:203]
  ds_read_b128 a[212:215], v22 offset:33024
  v_mfma_f32_16x16x32_bf16 v[200:203], a[252:255], v[140:143], v[200:203]
  ds_read_b128 a[216:219], v23 offset:33024
  v_mfma_f32_16x16x32_bf16 v[216:219], a[236:239], v[120:123], v[216:219]
  v_exp_f32 v76, v76
  v_mfma_f32_16x16x32_bf16 v[216:219], a[252:255], v[144:147], v[216:219]
  ds_read_b128 a[220:223], v24 offset:33024
  v_mfma_f32_16x16x32_bf16 v[232:235], a[236:239], v[124:127], v[232:235]
  v_exp_f32 v77, v77
  v_mfma_f32_16x16x32_bf16 v[232:235], a[252:255], v[148:151], v[232:235]
  buffer_load_dwordx4 v12, s[16:19], s6 offen offset:2048 nt lds
  v_mfma_f32_16x16x32_bf16 v[248:251], a[236:239], v[128:131], v[248:251]
  v_exp_f32 v78, v78
  v_mfma_f32_16x16x32_bf16 v[248:251], a[252:255], v[152:155], v[248:251]
  v_exp_f32 v79, v79
  s_waitcnt lgkmcnt(8)
  v_mfma_f32_16x16x32_bf16 v[60:63], a[192:195], a[0:3], 0
  v_add_f32 v52, v52, v76
  v_add_f32 v52, v52, v77
  s_waitcnt lgkmcnt(7)
  v_mfma_f32_16x16x32_bf16 v[60:63], a[196:199], a[24:27], v[60:63]
  v_cvt_pk_bf16_f32 v76, v76, v77
  v_add_f32 v52, v52, v78
  s_waitcnt lgkmcnt(6)
  v_mfma_f32_16x16x32_bf16 v[60:63], a[200:203], a[48:51], v[60:63]
  v_add_f32 v52, v52, v79
  v_cvt_pk_bf16_f32 v77, v78, v79
  s_waitcnt lgkmcnt(5)
  v_mfma_f32_16x16x32_bf16 v[60:63], a[204:207], a[72:75], v[60:63]
  ds_write_b64 v33, v[76:77] offset:4096
  s_waitcnt lgkmcnt(5)
  v_mfma_f32_16x16x32_bf16 v[60:63], a[208:211], a[96:99], v[60:63]
  buffer_load_dwordx4 v13, s[16:19], s6 offen offset:3072 nt lds
  s_waitcnt lgkmcnt(3)
  v_mfma_f32_16x16x32_bf16 v[60:63], a[212:215], a[120:123], v[60:63]
  v_exp_f32 v80, v80
  s_waitcnt lgkmcnt(2)
  v_mfma_f32_16x16x32_bf16 v[60:63], a[216:219], a[144:147], v[60:63]
  v_exp_f32 v81, v81
  s_waitcnt lgkmcnt(1)
  v_mfma_f32_16x16x32_bf16 v[60:63], a[220:223], a[168:171], v[60:63]
  v_exp_f32 v82, v82
  v_mfma_f32_16x16x32_bf16 v[64:67], a[192:195], a[4:7], 0
  s_add_u32 m0, s65, 4096
  s_xor_b32 s6, s63, 237568
  v_mfma_f32_16x16x32_bf16 v[64:67], a[196:199], a[28:31], v[64:67]
  v_exp_f32 v83, v83
  v_mfma_f32_16x16x32_bf16 v[64:67], a[200:203], a[52:55], v[64:67]
  v_add_f32 v53, v53, v80
  v_add_f32 v53, v53, v81
  v_mfma_f32_16x16x32_bf16 v[64:67], a[204:207], a[76:79], v[64:67]
  buffer_load_dwordx4 v10, s[16:19], s6 offen nt lds
  v_cvt_pk_bf16_f32 v80, v80, v81
  v_mfma_f32_16x16x32_bf16 v[64:67], a[208:211], a[100:103], v[64:67]
  v_add_f32 v53, v53, v82
  v_add_f32 v53, v53, v83
  v_mfma_f32_16x16x32_bf16 v[64:67], a[212:215], a[124:127], v[64:67]
  v_cvt_pk_bf16_f32 v81, v82, v83
  v_mfma_f32_16x16x32_bf16 v[64:67], a[216:219], a[148:151], v[64:67]
  ds_write_b64 v33, v[80:81] offset:5120
  v_mfma_f32_16x16x32_bf16 v[64:67], a[220:223], a[172:175], v[64:67]
  v_mfma_f32_16x16x32_bf16 v[68:71], a[192:195], a[8:11], 0
  v_mfma_f32_16x16x32_bf16 v[68:71], a[196:199], a[32:35], v[68:71]
  v_mfma_f32_16x16x32_bf16 v[68:71], a[200:203], a[56:59], v[68:71]
  buffer_load_dwordx4 v11, s[16:19], s6 offen offset:1024 nt lds
  v_mfma_f32_16x16x32_bf16 v[68:71], a[204:207], a[80:83], v[68:71]
  s_waitcnt lgkmcnt(0)
  s_barrier
  ds_read_b128 v[108:111], v34
  v_mfma_f32_16x16x32_bf16 v[68:71], a[208:211], a[104:107], v[68:71]
  v_fma_f32 v60, v60, s94, v54
  v_fma_f32 v61, v61, s94, v54
  v_mfma_f32_16x16x32_bf16 v[68:71], a[212:215], a[128:131], v[68:71]
  ds_read_b128 v[112:115], v34 offset:1024
  v_fma_f32 v62, v62, s94, v54
  v_mfma_f32_16x16x32_bf16 v[68:71], a[216:219], a[152:155], v[68:71]
  v_fma_f32 v63, v63, s94, v54
  v_fma_f32 v64, v64, s94, v55
  v_mfma_f32_16x16x32_bf16 v[68:71], a[220:223], a[176:179], v[68:71]
  ds_read_b128 v[116:119], v34 offset:2048
  v_fma_f32 v65, v65, s94, v55
  v_mfma_f32_16x16x32_bf16 v[72:75], a[192:195], a[12:15], 0
  v_exp_f32 v60, v60
  v_mfma_f32_16x16x32_bf16 v[72:75], a[196:199], a[36:39], v[72:75]
  buffer_load_dwordx4 v12, s[16:19], s6 offen offset:2048 nt lds
  v_fma_f32 v66, v66, s94, v55
  v_mfma_f32_16x16x32_bf16 v[72:75], a[200:203], a[60:63], v[72:75]
  ds_read_b128 v[120:123], v34 offset:3072
  v_fma_f32 v67, v67, s94, v55
  v_mfma_f32_16x16x32_bf16 v[72:75], a[204:207], a[84:87], v[72:75]
  v_exp_f32 v61, v61
  v_mfma_f32_16x16x32_bf16 v[72:75], a[208:211], a[108:111], v[72:75]
  ds_read_b128 v[124:127], v34 offset:4096
  v_fma_f32 v68, v68, s94, v56
  v_mfma_f32_16x16x32_bf16 v[72:75], a[212:215], a[132:135], v[72:75]
  v_exp_f32 v62, v62
  v_mfma_f32_16x16x32_bf16 v[72:75], a[216:219], a[156:159], v[72:75]
  ds_read_b128 v[128:131], v34 offset:5120
  v_fma_f32 v69, v69, s94, v56
  v_mfma_f32_16x16x32_bf16 v[72:75], a[220:223], a[180:183], v[72:75]
  v_exp_f32 v63, v63
  v_mfma_f32_16x16x32_bf16 v[76:79], a[192:195], a[16:19], 0
  buffer_load_dwordx4 v13, s[16:19], s6 offen offset:3072 nt lds
  v_add_f32 v48, v48, v60
  v_mfma_f32_16x16x32_bf16 v[76:79], a[196:199], a[40:43], v[76:79]
  v_add_f32 v48, v48, v61
  v_cvt_pk_bf16_f32 v60, v60, v61
  v_mfma_f32_16x16x32_bf16 v[76:79], a[200:203], a[64:67], v[76:79]
  s_waitcnt vmcnt(12)
  ds_read_b64_tr_b16 a[224:225], v25 offset:8192
  v_add_f32 v48, v48, v62
  v_mfma_f32_16x16x32_bf16 v[76:79], a[204:207], a[88:91], v[76:79]
  v_add_f32 v48, v48, v63
  v_cvt_pk_bf16_f32 v61, v62, v63
  v_mfma_f32_16x16x32_bf16 v[76:79], a[208:211], a[112:115], v[76:79]
  ds_read_b64_tr_b16 a[226:227], v25 offset:10240
  v_fma_f32 v70, v70, s94, v56
  v_mfma_f32_16x16x32_bf16 v[76:79], a[212:215], a[136:139], v[76:79]
  ds_write_b64 v33, v[60:61] offset:12288
  v_mfma_f32_16x16x32_bf16 v[76:79], a[216:219], a[160:163], v[76:79]
  v_exp_f32 v64, v64
  v_mfma_f32_16x16x32_bf16 v[76:79], a[220:223], a[184:187], v[76:79]
  v_exp_f32 v65, v65
  v_mfma_f32_16x16x32_bf16 v[80:83], a[192:195], a[20:23], 0
  ds_read_b64_tr_b16 a[228:229], v26 offset:8192
  v_fma_f32 v71, v71, s94, v56
  v_mfma_f32_16x16x32_bf16 v[80:83], a[196:199], a[44:47], v[80:83]
  v_exp_f32 v66, v66
  v_mfma_f32_16x16x32_bf16 v[80:83], a[200:203], a[68:71], v[80:83]
  ds_read_b64_tr_b16 a[230:231], v26 offset:10240
  v_fma_f32 v72, v72, s94, v57
  v_mfma_f32_16x16x32_bf16 v[80:83], a[204:207], a[92:95], v[80:83]
  v_exp_f32 v67, v67
  v_mfma_f32_16x16x32_bf16 v[80:83], a[208:211], a[116:119], v[80:83]
  v_add_f32 v49, v49, v64
  v_add_f32 v49, v49, v65
  v_mfma_f32_16x16x32_bf16 v[80:83], a[212:215], a[140:143], v[80:83]
  v_cvt_pk_bf16_f32 v64, v64, v65
  v_add_f32 v49, v49, v66
  v_mfma_f32_16x16x32_bf16 v[80:83], a[216:219], a[164:167], v[80:83]
  ds_read_b64_tr_b16 a[232:233], v27 offset:8192
  v_add_f32 v49, v49, v67
  v_mfma_f32_16x16x32_bf16 v[80:83], a[220:223], a[188:191], v[80:83]
  v_cvt_pk_bf16_f32 v65, v66, v67
  v_fma_f32 v73, v73, s94, v57
  s_waitcnt lgkmcnt(4)
  v_mfma_f32_16x16x32_bf16 v[156:159], a[224:227], v[108:111], v[156:159]
  ds_write_b64 v33, v[64:65] offset:13312
  v_mfma_f32_16x16x32_bf16 v[172:175], a[224:227], v[112:115], v[172:175]
  ds_read_b64_tr_b16 a[234:235], v27 offset:10240
  s_add_u32 m0, s64, 0
  v_mfma_f32_16x16x32_bf16 v[188:191], a[224:227], v[116:119], v[188:191]
  s_add_u32 s6, s83, 0
  v_exp_f32 v68, v68
  v_mfma_f32_16x16x32_bf16 v[204:207], a[224:227], v[120:123], v[204:207]
  buffer_load_dwordx4 v96, s[24:27], s6 offen lds
  v_fma_f32 v74, v74, s94, v57
  v_mfma_f32_16x16x32_bf16 v[220:223], a[224:227], v[124:127], v[220:223]
  v_exp_f32 v69, v69
  v_mfma_f32_16x16x32_bf16 v[236:239], a[224:227], v[128:131], v[236:239]
  v_exp_f32 v70, v70
  s_waitcnt lgkmcnt(3)
  v_mfma_f32_16x16x32_bf16 v[160:163], a[228:231], v[108:111], v[160:163]
  ds_read_b64_tr_b16 a[236:237], v28 offset:8192
  v_fma_f32 v75, v75, s94, v57
  v_mfma_f32_16x16x32_bf16 v[176:179], a[228:231], v[112:115], v[176:179]
  v_exp_f32 v71, v71
  v_mfma_f32_16x16x32_bf16 v[192:195], a[228:231], v[116:119], v[192:195]
  ds_read_b64_tr_b16 a[238:239], v28 offset:10240
  v_add_f32 v50, v50, v68
  v_mfma_f32_16x16x32_bf16 v[208:211], a[228:231], v[120:123], v[208:211]
  buffer_load_dwordx4 v97, s[24:27], s6 offen offset:1024 lds
  v_add_f32 v50, v50, v69
  v_mfma_f32_16x16x32_bf16 v[224:227], a[228:231], v[124:127], v[224:227]
  s_waitcnt vmcnt(10)
  ds_read_b128 v[132:135], v34 offset:6144
  v_cvt_pk_bf16_f32 v68, v68, v69
  v_mfma_f32_16x16x32_bf16 v[240:243], a[228:231], v[128:131], v[240:243]
  ds_read_b128 v[136:139], v34 offset:7168
  v_add_f32 v50, v50, v70
  s_waitcnt lgkmcnt(4)
  v_mfma_f32_16x16x32_bf16 v[164:167], a[232:235], v[108:111], v[164:167]
  ds_read_b128 v[140:143], v34 offset:8192
  v_add_f32 v50, v50, v71
  v_cvt_pk_bf16_f32 v69, v70, v71
  ds_write_b64 v33, v[68:69] offset:14336
  v_mfma_f32_16x16x32_bf16 v[180:183], a[232:235], v[112:115], v[180:183]
  ds_read_b128 v[144:147], v34 offset:9216
  v_fma_f32 v76, v76, s94, v58
  v_mfma_f32_16x16x32_bf16 v[196:199], a[232:235], v[116:119], v[196:199]
  ds_read_b64_tr_b16 a[240:241], v25 offset:12288
  v_fma_f32 v77, v77, s94, v58
  v_mfma_f32_16x16x32_bf16 v[212:215], a[232:235], v[120:123], v[212:215]
  buffer_load_dwordx4 v98, s[24:27], s6 offen offset:2048 lds
  v_fma_f32 v78, v78, s94, v58
  v_mfma_f32_16x16x32_bf16 v[228:231], a[232:235], v[124:127], v[228:231]
  ds_read_b128 v[148:151], v34 offset:10240
  v_fma_f32 v79, v79, s94, v58
  v_mfma_f32_16x16x32_bf16 v[244:247], a[232:235], v[128:131], v[244:247]
  ds_read_b64_tr_b16 a[242:243], v25 offset:14336
  v_fma_f32 v80, v80, s94, v59
  s_waitcnt lgkmcnt(8)
  v_mfma_f32_16x16x32_bf16 v[168:171], a[236:239], v[108:111], v[168:171]
  ds_read_b128 v[152:155], v34 offset:11264
  v_fma_f32 v81, v81, s94, v59
  v_mfma_f32_16x16x32_bf16 v[184:187], a[236:239], v[112:115], v[184:187]
  v_exp_f32 v72, v72
  v_mfma_f32_16x16x32_bf16 v[200:203], a[236:239], v[116:119], v[200:203]
  v_exp_f32 v73, v73
  v_exp_f32 v74, v74
  v_exp_f32 v75, v75
  v_add_f32 v51, v51, v72
  v_add_f32 v51, v51, v73
  v_cvt_pk_bf16_f32 v72, v72, v73
  v_add_f32 v51, v51, v74
  v_add_f32 v51, v51, v75
  v_cvt_pk_bf16_f32 v73, v74, v75
  ds_write_b64 v33, v[72:73] offset:15360
  v_mfma_f32_16x16x32_bf16 v[216:219], a[236:239], v[120:123], v[216:219]
  buffer_load_dwordx4 v99, s[24:27], s6 offen offset:3072 lds
  v_fma_f32 v82, v82, s94, v59
  v_mfma_f32_16x16x32_bf16 v[232:235], a[236:239], v[124:127], v[232:235]
  ds_read_b64_tr_b16 a[244:245], v26 offset:12288
  v_fma_f32 v83, v83, s94, v59
  v_mfma_f32_16x16x32_bf16 v[248:251], a[236:239], v[128:131], v[248:251]
  ds_read_b64_tr_b16 a[246:247], v26 offset:14336
  s_waitcnt lgkmcnt(4)
  v_mfma_f32_16x16x32_bf16 v[156:159], a[240:243], v[132:135], v[156:159]
  s_add_u32 m0, s64, 4096
  s_add_u32 s6, s83, 28672
  v_mfma_f32_16x16x32_bf16 v[172:175], a[240:243], v[136:139], v[172:175]
  v_exp_f32 v76, v76
  v_mfma_f32_16x16x32_bf16 v[188:191], a[240:243], v[140:143], v[188:191]
  v_exp_f32 v77, v77
  v_mfma_f32_16x16x32_bf16 v[204:207], a[240:243], v[144:147], v[204:207]
  buffer_load_dwordx4 v96, s[24:27], s6 offen lds
  v_mfma_f32_16x16x32_bf16 v[220:223], a[240:243], v[148:151], v[220:223]
  v_exp_f32 v78, v78
  v_exp_f32 v79, v79
  v_add_f32 v52, v52, v76
  v_add_f32 v52, v52, v77
  v_cvt_pk_bf16_f32 v76, v76, v77
  v_add_f32 v52, v52, v78
  v_add_f32 v52, v52, v79
  v_cvt_pk_bf16_f32 v77, v78, v79
  ds_write_b64 v33, v[76:77] offset:16384
  s_waitcnt lgkmcnt(4)
  v_mfma_f32_16x16x32_bf16 v[236:239], a[240:243], v[152:155], v[236:239]
  ds_read_b64_tr_b16 a[248:249], v27 offset:12288
  s_waitcnt lgkmcnt(2)
  v_mfma_f32_16x16x32_bf16 v[160:163], a[244:247], v[132:135], v[160:163]
  ds_read_b64_tr_b16 a[250:251], v27 offset:14336
  v_mfma_f32_16x16x32_bf16 v[176:179], a[244:247], v[136:139], v[176:179]
  v_exp_f32 v80, v80
  v_mfma_f32_16x16x32_bf16 v[192:195], a[244:247], v[140:143], v[192:195]
  v_exp_f32 v81, v81
  v_mfma_f32_16x16x32_bf16 v[208:211], a[244:247], v[144:147], v[208:211]
  buffer_load_dwordx4 v97, s[24:27], s6 offen offset:1024 lds
  v_mfma_f32_16x16x32_bf16 v[224:227], a[244:247], v[148:151], v[224:227]
  v_exp_f32 v82, v82
  v_mfma_f32_16x16x32_bf16 v[240:243], a[244:247], v[152:155], v[240:243]
  ds_read_b64_tr_b16 a[252:253], v28 offset:12288
  s_waitcnt lgkmcnt(1)
  v_mfma_f32_16x16x32_bf16 v[164:167], a[248:251], v[132:135], v[164:167]
  v_exp_f32 v83, v83
  ds_read_b64_tr_b16 a[254:255], v28 offset:14336
  v_add_f32 v53, v53, v80
  v_add_f32 v53, v53, v81
  v_cvt_pk_bf16_f32 v80, v80, v81
  v_add_f32 v53, v53, v82
  v_add_f32 v53, v53, v83
  v_cvt_pk_bf16_f32 v81, v82, v83
  ds_write_b64 v33, v[80:81] offset:17408
  v_mfma_f32_16x16x32_bf16 v[180:183], a[248:251], v[136:139], v[180:183]
  v_permlane32_swap_b32 v48, v49
  v_permlane32_swap_b32 v50, v51
  v_mfma_f32_16x16x32_bf16 v[196:199], a[248:251], v[140:143], v[196:199]
  s_waitcnt lgkmcnt(0)
  s_barrier
  ds_read_b128 v[120:123], v34 offset:15360
  v_permlane32_swap_b32 v52, v53
  v_mfma_f32_16x16x32_bf16 v[212:215], a[248:251], v[144:147], v[212:215]
  s_waitcnt vmcnt(10)
  ds_read_b128 v[124:127], v34 offset:16384
  v_add_f32 v48, v48, v49
  v_mfma_f32_16x16x32_bf16 v[228:231], a[248:251], v[148:151], v[228:231]
  buffer_load_dwordx4 v98, s[24:27], s6 offen offset:2048 lds
  v_add_f32 v50, v50, v51
  v_mfma_f32_16x16x32_bf16 v[244:247], a[248:251], v[152:155], v[244:247]
  ds_read_b128 v[128:131], v34 offset:17408
  v_add_f32 v52, v52, v53
  v_mfma_f32_16x16x32_bf16 v[168:171], a[252:255], v[132:135], v[168:171]
  ds_read_b64_tr_b16 a[224:225], v25
  v_mov_b32 v53, v52
  v_mfma_f32_16x16x32_bf16 v[184:187], a[252:255], v[136:139], v[184:187]
  ds_read_b64_tr_b16 a[226:227], v25 offset:2048
  v_permlane16_swap_b32 v48, v50
  v_mfma_f32_16x16x32_bf16 v[200:203], a[252:255], v[140:143], v[200:203]
  ds_read_b64_tr_b16 a[228:229], v26
  v_permlane16_swap_b32 v52, v53
  v_mfma_f32_16x16x32_bf16 v[216:219], a[252:255], v[144:147], v[216:219]
  ds_read_b64_tr_b16 a[230:231], v26 offset:2048
  v_add_f32 v48, v48, v50
  v_mfma_f32_16x16x32_bf16 v[232:235], a[252:255], v[148:151], v[232:235]
  buffer_load_dwordx4 v99, s[24:27], s6 offen offset:3072 lds
  v_add_f32 v52, v52, v53
  v_mfma_f32_16x16x32_bf16 v[248:251], a[252:255], v[152:155], v[248:251]
  ds_read_b64_tr_b16 a[232:233], v27
  ds_read_b64_tr_b16 a[234:235], v27 offset:2048
  ds_read_b64_tr_b16 a[236:237], v28
  ds_read_b64_tr_b16 a[238:239], v28 offset:2048
  s_waitcnt lgkmcnt(6)
  v_mfma_f32_16x16x32_bf16 v[204:207], a[224:227], v[120:123], v[204:207]
  ds_write_b32 v36, v48
  v_mfma_f32_16x16x32_bf16 v[220:223], a[224:227], v[124:127], v[220:223]
  ds_read_b128 v[108:111], v34 offset:12288
  s_add_u32 m0, s64, 32768
  v_mfma_f32_16x16x32_bf16 v[236:239], a[224:227], v[128:131], v[236:239]
  ds_write_b32 v36, v52 offset:1024
  s_waitcnt lgkmcnt(7)
  v_mfma_f32_16x16x32_bf16 v[208:211], a[228:231], v[120:123], v[208:211]
  ds_read_b128 v[112:115], v34 offset:13312
  s_add_u32 s6, s83, 57344
  v_mfma_f32_16x16x32_bf16 v[224:227], a[228:231], v[124:127], v[224:227]
  buffer_load_dwordx4 v96, s[24:27], s6 offen lds
  v_mfma_f32_16x16x32_bf16 v[240:243], a[228:231], v[128:131], v[240:243]
  ds_read_b128 v[116:119], v34 offset:14336
  s_waitcnt lgkmcnt(7)
  v_mfma_f32_16x16x32_bf16 v[212:215], a[232:235], v[120:123], v[212:215]
  ds_read_b128 v[144:147], v34 offset:21504
  ds_read_b128 v[148:151], v34 offset:22528
  ds_read_b128 v[152:155], v34 offset:23552
  v_mfma_f32_16x16x32_bf16 v[228:231], a[232:235], v[124:127], v[228:231]
  s_waitcnt lgkmcnt(5)
  s_barrier
  ds_read_b128 v[60:63], v37
  v_mfma_f32_16x16x32_bf16 v[244:247], a[232:235], v[128:131], v[244:247]
  ds_read_b128 v[64:67], v37 offset:512
  v_mfma_f32_16x16x32_bf16 v[216:219], a[236:239], v[120:123], v[216:219]
  ds_read_b128 v[68:71], v37 offset:256
  v_mfma_f32_16x16x32_bf16 v[232:235], a[236:239], v[124:127], v[232:235]
  buffer_load_dwordx4 v97, s[24:27], s6 offen offset:1024 lds
  v_mfma_f32_16x16x32_bf16 v[248:251], a[236:239], v[128:131], v[248:251]
  ds_read_b128 v[72:75], v37 offset:768
  v_mfma_f32_16x16x32_bf16 v[156:159], a[224:227], v[108:111], v[156:159]
  ds_read_b128 v[76:79], v37 offset:1024
  s_waitcnt lgkmcnt(9)
  v_mfma_f32_16x16x32_bf16 v[172:175], a[224:227], v[112:115], v[172:175]
  ds_read_b128 v[80:83], v37 offset:1536
  s_waitcnt lgkmcnt(9)
  v_mfma_f32_16x16x32_bf16 v[188:191], a[224:227], v[116:119], v[188:191]
  v_mfma_f32_16x16x32_bf16 v[160:163], a[228:231], v[108:111], v[160:163]
  v_mfma_f32_16x16x32_bf16 v[176:179], a[228:231], v[112:115], v[176:179]
  s_waitcnt vmcnt(10)
  buffer_load_dwordx4 v98, s[24:27], s6 offen offset:2048 lds
  s_waitcnt lgkmcnt(5)
  v_add_f32 v60, v60, v61
  v_mfma_f32_16x16x32_bf16 v[192:195], a[228:231], v[116:119], v[192:195]
  ds_read_b64_tr_b16 a[240:241], v25 offset:4096
  v_add_f32 v62, v62, v63
  v_mfma_f32_16x16x32_bf16 v[164:167], a[232:235], v[108:111], v[164:167]
  ds_read_b64_tr_b16 a[242:243], v25 offset:6144
  v_add_f32 v48, v60, v62
  v_mfma_f32_16x16x32_bf16 v[180:183], a[232:235], v[112:115], v[180:183]
  ds_read_b64_tr_b16 a[244:245], v26 offset:4096
  s_waitcnt lgkmcnt(7)
  v_add_f32 v64, v64, v65
  v_mfma_f32_16x16x32_bf16 v[196:199], a[232:235], v[116:119], v[196:199]
  ds_read_b64_tr_b16 a[246:247], v26 offset:6144
  v_add_f32 v66, v66, v67
  v_mfma_f32_16x16x32_bf16 v[168:171], a[236:239], v[108:111], v[168:171]
  ds_read_b64_tr_b16 a[248:249], v27 offset:4096
  v_add_f32 v49, v64, v66
  v_mfma_f32_16x16x32_bf16 v[184:187], a[236:239], v[112:115], v[184:187]
  buffer_load_dwordx4 v99, s[24:27], s6 offen offset:3072 lds
  s_waitcnt lgkmcnt(8)
  v_add_f32 v68, v68, v69
  v_mfma_f32_16x16x32_bf16 v[200:203], a[236:239], v[116:119], v[200:203]
  ds_read_b64_tr_b16 a[250:251], v27 offset:6144
  v_add_f32 v70, v70, v71
  ds_read_b64_tr_b16 a[252:253], v28 offset:4096
  ds_read_b64_tr_b16 a[254:255], v28 offset:6144
  s_waitcnt lgkmcnt(6)
  v_mfma_f32_16x16x32_bf16 v[204:207], a[240:243], v[144:147], v[204:207]
  ds_read_b128 v[132:135], v34 offset:18432
  v_add_f32 v50, v68, v70
  v_mfma_f32_16x16x32_bf16 v[220:223], a[240:243], v[148:151], v[220:223]
  ds_read_b128 v[136:139], v34 offset:19456
  v_add_f32 v72, v72, v73
  v_mfma_f32_16x16x32_bf16 v[236:239], a[240:243], v[152:155], v[236:239]
  v_add_f32 v74, v74, v75
  v_add_f32 v51, v72, v74
  s_waitcnt lgkmcnt(6)
  v_mfma_f32_16x16x32_bf16 v[208:211], a[244:247], v[144:147], v[208:211]
  ds_read_b128 v[140:143], v34 offset:20480
  v_add_f32 v76, v76, v77
  v_mfma_f32_16x16x32_bf16 v[224:227], a[244:247], v[148:151], v[224:227]
  v_add_f32 v78, v78, v79
  v_add_f32 v52, v76, v78
  v_mfma_f32_16x16x32_bf16 v[240:243], a[244:247], v[152:155], v[240:243]
  v_add_f32 v80, v80, v81
  v_add_f32 v82, v82, v83
  s_waitcnt lgkmcnt(5)
  v_mfma_f32_16x16x32_bf16 v[212:215], a[248:251], v[144:147], v[212:215]
  v_add_f32 v53, v80, v82
  v_mfma_f32_16x16x32_bf16 v[228:231], a[248:251], v[148:151], v[228:231]
  buffer_store_dwordx4 v[50:53], v38, s[32:35], s86 offen sc1
  v_mfma_f32_16x16x32_bf16 v[244:247], a[248:251], v[152:155], v[244:247]
  buffer_store_dwordx4 v[56:59], v38, s[32:35], s86 offen offset:256 sc1
  s_waitcnt lgkmcnt(3)
  v_mfma_f32_16x16x32_bf16 v[216:219], a[252:255], v[144:147], v[216:219]
  v_cvt_pk_bf16_f32 v60, v204, v205
  v_cvt_pk_bf16_f32 v61, v206, v207
  v_mfma_f32_16x16x32_bf16 v[232:235], a[252:255], v[148:151], v[232:235]
  v_cvt_pk_bf16_f32 v62, v208, v209
  v_cvt_pk_bf16_f32 v63, v210, v211
  v_mfma_f32_16x16x32_bf16 v[248:251], a[252:255], v[152:155], v[248:251]
  buffer_store_dwordx4 v[60:63], v35, s[32:35], s84 offen sc1
  s_waitcnt lgkmcnt(2)
  v_mfma_f32_16x16x32_bf16 v[156:159], a[240:243], v[132:135], v[156:159]
  v_cvt_pk_bf16_f32 v64, v220, v221
  v_cvt_pk_bf16_f32 v65, v222, v223
  s_waitcnt lgkmcnt(1)
  v_mfma_f32_16x16x32_bf16 v[172:175], a[240:243], v[136:139], v[172:175]
  v_cvt_pk_bf16_f32 v66, v224, v225
  v_cvt_pk_bf16_f32 v67, v226, v227
  s_waitcnt lgkmcnt(0)
  v_mfma_f32_16x16x32_bf16 v[188:191], a[240:243], v[140:143], v[188:191]
  buffer_store_dwordx4 v[64:67], v35, s[32:35], s84 offen offset:1024 sc1
  v_mfma_f32_16x16x32_bf16 v[160:163], a[244:247], v[132:135], v[160:163]
  v_cvt_pk_bf16_f32 v68, v236, v237
  v_cvt_pk_bf16_f32 v69, v238, v239
  v_mfma_f32_16x16x32_bf16 v[176:179], a[244:247], v[136:139], v[176:179]
  v_cvt_pk_bf16_f32 v70, v240, v241
  v_cvt_pk_bf16_f32 v71, v242, v243
  v_mfma_f32_16x16x32_bf16 v[192:195], a[244:247], v[140:143], v[192:195]
  buffer_store_dwordx4 v[68:71], v35, s[32:35], s84 offen offset:2048 sc1
  v_mfma_f32_16x16x32_bf16 v[164:167], a[248:251], v[132:135], v[164:167]
L_it5:
  s_cbranch_execz L_it9
  v_cvt_pk_bf16_f32 v72, v212, v213
  v_cvt_pk_bf16_f32 v73, v214, v215
  v_mfma_f32_16x16x32_bf16 v[180:183], a[248:251], v[136:139], v[180:183]
  v_cvt_pk_bf16_f32 v74, v216, v217
  v_cvt_pk_bf16_f32 v75, v218, v219
  buffer_store_dwordx4 v[72:75], v35, s[32:35], s84 offen offset:3072 sc1
  v_cvt_pk_bf16_f32 v76, v228, v229
  v_cvt_pk_bf16_f32 v77, v230, v231
  v_cvt_pk_bf16_f32 v78, v232, v233
  v_cvt_pk_bf16_f32 v79, v234, v235
  s_add_u32 s82, s84, 4096
  buffer_store_dwordx4 v[76:79], v35, s[32:35], s82 offen sc1
  v_cvt_pk_bf16_f32 v80, v244, v245
  v_cvt_pk_bf16_f32 v81, v246, v247
  v_cvt_pk_bf16_f32 v82, v248, v249
  v_cvt_pk_bf16_f32 v83, v250, v251
  buffer_store_dwordx4 v[80:83], v35, s[32:35], s82 offen offset:1024 sc1
  v_mfma_f32_16x16x32_bf16 v[196:199], a[248:251], v[140:143], v[196:199]
  v_min3_f32 v43, v48, v49, v50
  v_min3_f32 v43, v43, v51, v52
  v_mfma_f32_16x16x32_bf16 v[168:171], a[252:255], v[132:135], v[168:171]
  v_min_f32 v43, v43, v53
  v_add_f32 v44, v48, v49
  v_mfma_f32_16x16x32_bf16 v[184:187], a[252:255], v[136:139], v[184:187]
  v_add_f32 v45, v50, v51
  v_add_f32 v46, v52, v53
  v_mfma_f32_16x16x32_bf16 v[200:203], a[252:255], v[140:143], v[200:203]
  v_add_f32 v44, v44, v45
  v_add_f32 v44, v44, v46
  v_cmp_nle_f32 vcc, 0x30800000, v43
  s_nop 0
  s_mov_b64 s[4:5], vcc
  v_cmp_nge_f32 vcc, 0x4e800000, v44
  s_nop 0
  s_or_b64 vcc, vcc, s[4:5]
  s_cbranch_vccnz L_fallback
L_checked:
  s_add_u32 m0, s64, 36864
  s_add_u32 s6, s83, 86016
  buffer_load_dwordx4 v96, s[24:27], s6 offen lds
  buffer_load_dwordx4 v97, s[24:27], s6 offen offset:1024 lds
  buffer_load_dwordx4 v98, s[24:27], s6 offen offset:2048 lds
  buffer_load_dwordx4 v99, s[24:27], s6 offen offset:3072 lds
  v_readfirstlane_b32 s5, v39
  s_nop 0
  s_cmp_eq_u32 s5, 0
  s_cbranch_scc1 L_gowait
L_go:
  s_waitcnt vmcnt(12)
  ds_read_b64_tr_b16 a[0:1], v92
  ds_read_b64_tr_b16 a[2:3], v92 offset:2048
  ds_read_b64_tr_b16 a[4:5], v93
  ds_read_b64_tr_b16 a[6:7], v93 offset:2048
  ds_read_b64_tr_b16 a[8:9], v94
  ds_read_b64_tr_b16 a[10:11], v94 offset:2048
  ds_read_b64_tr_b16 a[12:13], v95
  ds_read_b64_tr_b16 a[14:15], v95 offset:2048
  ds_read_b64_tr_b16 a[16:17], v92 offset:4096
  ds_read_b64_tr_b16 a[18:19], v92 offset:6144
  ds_read_b64_tr_b16 a[20:21], v93 offset:4096
  ds_read_b64_tr_b16 a[22:23], v93 offset:6144
  ds_read_b64_tr_b16 a[24:25], v94 offset:4096
  ds_read_b64_tr_b16 a[26:27], v94 offset:6144
  ds_read_b64_tr_b16 a[28:29], v95 offset:4096
  ds_read_b64_tr_b16 a[30:31], v95 offset:6144
  ds_read_b64_tr_b16 a[32:33], v92 offset:32768
  ds_read_b64_tr_b16 a[34:35], v92 offset:34816
  ds_read_b64_tr_b16 a[36:37], v93 offset:32768
  ds_read_b64_tr_b16 a[38:39], v93 offset:34816
  ds_read_b64_tr_b16 a[40:41], v94 offset:32768
  ds_read_b64_tr_b16 a[42:43], v94 offset:34816
  ds_read_b64_tr_b16 a[44:45], v95 offset:32768
  ds_read_b64_tr_b16 a[46:47], v95 offset:34816
  s_barrier
  s_waitcnt lgkmcnt(0)
  s_waitcnt vmcnt(4)
  s_mov_b32 s5, 1
  s_atomic_add s5, s[54:55], s88
  s_add_u32 m0, s65, 8192
  s_add_u32 s6, s83, 114688
  buffer_load_dwordx4 v96, s[24:27], s6 offen lds
  buffer_load_dwordx4 v97, s[24:27], s6 offen offset:1024 lds
  buffer_load_dwordx4 v98, s[24:27], s6 offen offset:2048 lds
  buffer_load_dwordx4 v99, s[24:27], s6 offen offset:3072 lds
  s_add_u32 m0, s65, 12288
  s_add_u32 s6, s83, 143360
  buffer_load_dwordx4 v96, s[24:27], s6 offen lds
  buffer_load_dwordx4 v97, s[24:27], s6 offen offset:1024 lds
  buffer_load_dwordx4 v98, s[24:27], s6 offen offset:2048 lds
  buffer_load_dwordx4 v99, s[24:27], s6 offen offset:3072 lds
  s_load_dword s82, s[54:55], s89 glc
  s_add_u32 m0, s65, 0
  s_add_u32 s6, s83, 172032
  buffer_load_dwordx4 v96, s[24:27], s6 offen lds
  buffer_load_dwordx4 v97, s[24:27], s6 offen offset:1024 lds
  buffer_load_dwordx4 v98, s[24:27], s6 offen offset:2048 lds
  buffer_load_dwordx4 v99, s[24:27], s6 offen offset:3072 lds
  s_add_u32 m0, s65, 4096
  s_add_u32 s6, s83, 200704
  buffer_load_dwordx4 v96, s[24:27], s6 offen lds
  buffer_load_dwordx4 v97, s[24:27], s6 offen offset:1024 lds
  buffer_load_dwordx4 v98, s[24:27], s6 offen offset:2048 lds
  buffer_load_dwordx4 v99, s[24:27], s6 offen offset:3072 lds
  s_cmp_eq_u32 s56, 3
  s_cbranch_scc1 L_w3
  s_waitcnt lgkmcnt(0)
  s_add_u32 m0, s64, 0
  s_add_u32 s6, s83, 128
  buffer_load_dwordx4 v96, s[24:27], s6 offen lds
  buffer_load_dwordx4 v97, s[24:27], s6 offen offset:1024 lds
  buffer_load_dwordx4 v98, s[24:27], s6 offen offset:2048 lds
  buffer_load_dwordx4 v99, s[24:27], s6 offen offset:3072 lds
  s_cmp_eq_u32 s82, 0
  s_cbranch_scc1 L_poll1
L_poll1x:
  buffer_load_dwordx4 v[132:135], v38, s[32:35], s87 offen sc1
  buffer_load_dwordx4 v[136:139], v38, s[32:35], s87 offen offset:256 sc1
  s_add_u32 s82, s85, 4096
  buffer_load_dwordx4 v[108:111], v35, s[32:35], s85 offen sc1
  buffer_load_dwordx4 v[112:115], v35, s[32:35], s85 offen offset:1024 sc1
  buffer_load_dwordx4 v[116:119], v35, s[32:35], s85 offen offset:2048 sc1
  buffer_load_dwordx4 v[120:123], v35, s[32:35], s85 offen offset:3072 sc1
  buffer_load_dwordx4 v[124:127], v35, s[32:35], s82 offen sc1
  buffer_load_dwordx4 v[128:131], v35, s[32:35], s82 offen offset:1024 sc1
  s_waitcnt vmcnt(12)
  ds_read_b64_tr_b16 a[48:49], v92 offset:36864
  ds_read_b64_tr_b16 a[50:51], v92 offset:38912
  ds_read_b64_tr_b16 a[52:53], v93 offset:36864
  ds_read_b64_tr_b16 a[54:55], v93 offset:38912
  ds_read_b64_tr_b16 a[56:57], v94 offset:36864
  ds_read_b64_tr_b16 a[58:59], v94 offset:38912
  ds_read_b64_tr_b16 a[60:61], v95 offset:36864
  ds_read_b64_tr_b16 a[62:63], v95 offset:38912
  ds_read_b64_tr_b16 a[64:65], v25 offset:8192
  ds_read_b64_tr_b16 a[66:67], v25 offset:10240
  ds_read_b64_tr_b16 a[68:69], v26 offset:8192
  ds_read_b64_tr_b16 a[70:71], v26 offset:10240
  ds_read_b64_tr_b16 a[72:73], v27 offset:8192
  ds_read_b64_tr_b16 a[74:75], v27 offset:10240
  ds_read_b64_tr_b16 a[76:77], v28 offset:8192
  ds_read_b64_tr_b16 a[78:79], v28 offset:10240
  ds_read_b64_tr_b16 a[80:81], v25 offset:12288
  ds_read_b64_tr_b16 a[82:83], v25 offset:14336
  ds_read_b64_tr_b16 a[84:85], v26 offset:12288
  ds_read_b64_tr_b16 a[86:87], v26 offset:14336
  ds_read_b64_tr_b16 a[88:89], v27 offset:12288
  ds_read_b64_tr_b16 a[90:91], v27 offset:14336
  ds_read_b64_tr_b16 a[92:93], v28 offset:12288
  ds_read_b64_tr_b16 a[94:95], v28 offset:14336
  ds_read_b64_tr_b16 a[96:97], v25
  ds_read_b64_tr_b16 a[98:99], v25 offset:2048
  ds_read_b64_tr_b16 a[100:101], v26
  ds_read_b64_tr_b16 a[102:103], v26 offset:2048
  ds_read_b64_tr_b16 a[104:105], v27
  ds_read_b64_tr_b16 a[106:107], v27 offset:2048
  ds_read_b64_tr_b16 a[108:109], v28
  ds_read_b64_tr_b16 a[110:111], v28 offset:2048
  ds_read_b64_tr_b16 a[112:113], v25 offset:4096
  ds_read_b64_tr_b16 a[114:115], v25 offset:6144
  ds_read_b64_tr_b16 a[116:117], v26 offset:4096
  ds_read_b64_tr_b16 a[118:119], v26 offset:6144
  ds_read_b64_tr_b16 a[120:121], v27 offset:4096
  ds_read_b64_tr_b16 a[122:123], v27 offset:6144
  ds_read_b64_tr_b16 a[124:125], v28 offset:4096
  ds_read_b64_tr_b16 a[126:127], v28 offset:6144
  s_waitcnt vmcnt(6)
  v_cmp_neq_f32 vcc, v54, v137
  v_cmp_neq_f32 s[4:5], v55, v138
  v_cmp_neq_f32 s[72:73], v56, v139
  s_waitcnt lgkmcnt(0)
  s_add_u32 m0, s64, 4096
  s_add_u32 s6, s83, 28800
  buffer_load_dwordx4 v96, s[24:27], s6 offen lds
  buffer_load_dwordx4 v97, s[24:27], s6 offen offset:1024 lds
  s_or_b64 vcc, vcc, s[4:5]
  s_or_b64 vcc, vcc, s[72:73]
  s_cbranch_vccnz L_rescale
L_rescaled:
  v_add_f32 v48, v48, v133
  v_add_f32 v49, v49, v134
  v_add_f32 v50, v50, v135
  v_rcp_f32 v48, v48
  v_rcp_f32 v49, v49
  v_rcp_f32 v50, v50
  s_waitcnt vmcnt(7)
  v_mfma_f32_16x16x32_bf16 v[156:159], v[86:89], v[108:111], v[156:159]
  v_mfma_f32_16x16x32_bf16 v[160:163], v[84:87], v[108:111], v[160:163]
  buffer_load_dwordx4 v98, s[24:27], s6 offen offset:2048 lds
  s_waitcnt vmcnt(7)
  v_mfma_f32_16x16x32_bf16 v[172:175], v[86:89], v[112:115], v[172:175]
  v_mfma_f32_16x16x32_bf16 v[176:179], v[84:87], v[112:115], v[176:179]
  buffer_load_dwordx4 v99, s[24:27], s6 offen offset:3072 lds
  s_nop 2
  v_cvt_pk_bf16_f32 v60, v156, v157
  v_cvt_pk_bf16_f32 v61, v158, v159
  v_cvt_pk_bf16_f32 v62, v160, v161
  v_cvt_pk_bf16_f32 v63, v162, v163
  ds_write_b128 v42, v[60:63]
  s_waitcnt vmcnt(7)
  v_mfma_f32_16x16x32_bf16 v[188:191], v[86:89], v[116:119], v[188:191]
  v_mfma_f32_16x16x32_bf16 v[192:195], v[84:87], v[116:119], v[192:195]
  s_add_u32 m0, s64, 32768
  s_add_u32 s6, s83, 57472
  buffer_load_dwordx4 v96, s[24:27], s6 offen lds
  v_cvt_pk_bf16_f32 v64, v172, v173
  v_cvt_pk_bf16_f32 v65, v174, v175
  v_cvt_pk_bf16_f32 v66, v176, v177
  v_cvt_pk_bf16_f32 v67, v178, v179
  ds_write_b128 v42, v[64:67] offset:1024
  s_waitcnt vmcnt(7)
  v_mfma_f32_16x16x32_bf16 v[164:167], v[86:89], v[120:123], v[164:167]
  v_mfma_f32_16x16x32_bf16 v[168:171], v[84:87], v[120:123], v[168:171]
  buffer_load_dwordx4 v97, s[24:27], s6 offen offset:1024 lds
  v_cvt_pk_bf16_f32 v68, v188, v189
  v_cvt_pk_bf16_f32 v69, v190, v191
  v_cvt_pk_bf16_f32 v70, v192, v193
  v_cvt_pk_bf16_f32 v71, v194, v195
  ds_write_b128 v42, v[68:71] offset:2048
  s_waitcnt vmcnt(7)
  v_mfma_f32_16x16x32_bf16 v[180:183], v[86:89], v[124:127], v[180:183]
  v_mfma_f32_16x16x32_bf16 v[184:187], v[84:87], v[124:127], v[184:187]
  buffer_load_dwordx4 v98, s[24:27], s6 offen offset:2048 lds
  v_cvt_pk_bf16_f32 v72, v164, v165
  v_cvt_pk_bf16_f32 v73, v166, v167
  v_cvt_pk_bf16_f32 v74, v168, v169
  v_cvt_pk_bf16_f32 v75, v170, v171
  ds_write_b128 v42, v[72:75] offset:3072
  s_waitcnt vmcnt(7)
  v_mfma_f32_16x16x32_bf16 v[196:199], v[86:89], v[128:131], v[196:199]
  v_mfma_f32_16x16x32_bf16 v[200:203], v[84:87], v[128:131], v[200:203]
  buffer_load_dwordx4 v99, s[24:27], s6 offen offset:3072 lds
  v_cvt_pk_bf16_f32 v76, v180, v181
  v_cvt_pk_bf16_f32 v77, v182, v183
  v_cvt_pk_bf16_f32 v78, v184, v185
  v_cvt_pk_bf16_f32 v79, v186, v187
  ds_write_b128 v42, v[76:79] offset:4096
  s_add_u32 m0, s64, 36864
  s_add_u32 s6, s83, 86144
  buffer_load_dwordx4 v96, s[24:27], s6 offen lds
  v_cvt_pk_bf16_f32 v80, v196, v197
  v_cvt_pk_bf16_f32 v81, v198, v199
  v_cvt_pk_bf16_f32 v82, v200, v201
  v_cvt_pk_bf16_f32 v83, v202, v203
  ds_write_b128 v42, v[80:83] offset:5120
  buffer_load_dwordx4 v97, s[24:27], s6 offen offset:1024 lds
  s_waitcnt lgkmcnt(0)
  s_barrier
  ds_read_b128 v[156:159], v34
  ds_read_b128 v[168:171], v34 offset:3072
  ds_read_b128 v[180:183], v34 offset:6144
  ds_read_b128 v[192:195], v34 offset:9216
  ds_read_b128 v[204:207], v34 offset:12288
  ds_read_b128 v[216:219], v34 offset:15360
  buffer_load_dwordx4 v98, s[24:27], s6 offen offset:2048 lds
  buffer_load_dwordx4 v99, s[24:27], s6 offen offset:3072 lds
  s_add_u32 m0, s65, 8192
  s_add_u32 s6, s83, 114816
  s_waitcnt lgkmcnt(5)
  v_mfma_f32_16x16x32_bf16 v[108:111], a[0:3], v[156:159], 0
  ds_read_b128 v[228:231], v34 offset:18432
  s_waitcnt lgkmcnt(5)
  v_mfma_f32_16x16x32_bf16 v[108:111], a[16:19], v[168:171], v[108:111]
  ds_read_b128 v[240:243], v34 offset:21504
  v_mfma_f32_16x16x32_bf16 v[112:115], a[4:7], v[156:159], 0
  ds_read_b128 v[160:163], v34 offset:1024
  v_mfma_f32_16x16x32_bf16 v[112:115], a[20:23], v[168:171], v[112:115]
  ds_read_b128 v[172:175], v34 offset:4096
  s_waitcnt lgkmcnt(7)
  v_mfma_f32_16x16x32_bf16 v[108:111], a[32:35], v[180:183], v[108:111]
  buffer_load_dwordx4 v96, s[24:27], s6 offen lds
  s_waitcnt lgkmcnt(6)
  v_mfma_f32_16x16x32_bf16 v[108:111], a[48:51], v[192:195], v[108:111]
  ds_read_b128 v[184:187], v34 offset:7168
  v_mfma_f32_16x16x32_bf16 v[112:115], a[36:39], v[180:183], v[112:115]
  buffer_load_dwordx4 v97, s[24:27], s6 offen offset:1024 lds
  v_mfma_f32_16x16x32_bf16 v[112:115], a[52:55], v[192:195], v[112:115]
  ds_read_b128 v[196:199], v34 offset:10240
  s_waitcnt lgkmcnt(7)
  v_mfma_f32_16x16x32_bf16 v[108:111], a[64:67], v[204:207], v[108:111]
  buffer_load_dwordx4 v98, s[24:27], s6 offen offset:2048 lds
  s_waitcnt lgkmcnt(6)
  v_mfma_f32_16x16x32_bf16 v[108:111], a[80:83], v[216:219], v[108:111]
  ds_read_b128 v[208:211], v34 offset:13312
  v_mfma_f32_16x16x32_bf16 v[112:115], a[68:71], v[204:207], v[112:115]
  buffer_load_dwordx4 v99, s[24:27], s6 offen offset:3072 lds
  s_add_u32 m0, s65, 12288
  v_mfma_f32_16x16x32_bf16 v[112:115], a[84:87], v[216:219], v[112:115]
  ds_read_b128 v[220:223], v34 offset:16384
  s_add_u32 s6, s83, 143488
  s_waitcnt lgkmcnt(7)
  v_mfma_f32_16x16x32_bf16 v[108:111], a[96:99], v[228:231], v[108:111]
  buffer_load_dwordx4 v96, s[24:27], s6 offen lds
  s_waitcnt lgkmcnt(6)
  v_mfma_f32_16x16x32_bf16 v[108:111], a[112:115], v[240:243], v[108:111]
  ds_read_b128 v[232:235], v34 offset:19456
  v_mfma_f32_16x16x32_bf16 v[112:115], a[100:103], v[228:231], v[112:115]
  buffer_load_dwordx4 v97, s[24:27], s6 offen offset:1024 lds
  v_mfma_f32_16x16x32_bf16 v[112:115], a[116:119], v[240:243], v[112:115]
  ds_read_b128 v[244:247], v34 offset:22528
  s_waitcnt lgkmcnt(7)
  v_mfma_f32_16x16x32_bf16 v[116:119], a[0:3], v[160:163], 0
  buffer_load_dwordx4 v98, s[24:27], s6 offen offset:2048 lds
  s_waitcnt lgkmcnt(6)
  v_mfma_f32_16x16x32_bf16 v[116:119], a[16:19], v[172:175], v[116:119]
  ds_read_b128 v[164:167], v34 offset:2048
  v_mfma_f32_16x16x32_bf16 v[120:123], a[4:7], v[160:163], 0
  v_mfma_f32_16x16x32_bf16 v[120:123], a[20:23], v[172:175], v[120:123]
  ds_read_b128 v[176:179], v34 offset:5120
  s_add_u32 s77, s91, 0
  s_waitcnt lgkmcnt(7)
  v_mfma_f32_16x16x32_bf16 v[116:119], a[32:35], v[184:187], v[116:119]
  buffer_load_dwordx4 v99, s[24:27], s6 offen offset:3072 lds
  v_mul_f32 v108, v108, v48
  s_waitcnt lgkmcnt(6)
  v_mfma_f32_16x16x32_bf16 v[116:119], a[48:51], v[196:199], v[116:119]
  ds_read_b128 v[188:191], v34 offset:8192
  v_mul_f32 v109, v109, v48
  v_mfma_f32_16x16x32_bf16 v[120:123], a[36:39], v[184:187], v[120:123]
  s_add_u32 m0, s65, 0
  v_mul_f32 v110, v110, v48
  v_mul_f32 v111, v111, v48
  v_mfma_f32_16x16x32_bf16 v[120:123], a[52:55], v[196:199], v[120:123]
  ds_read_b128 v[200:203], v34 offset:11264
  v_cvt_pk_bf16_f32 v60, v108, v109
  s_waitcnt lgkmcnt(7)
  v_mfma_f32_16x16x32_bf16 v[116:119], a[64:67], v[208:211], v[116:119]
  s_add_u32 s6, s83, 172160
  v_cvt_pk_bf16_f32 v61, v110, v111
  v_mul_f32 v112, v112, v48
  s_waitcnt lgkmcnt(6)
  v_mfma_f32_16x16x32_bf16 v[116:119], a[80:83], v[220:223], v[116:119]
  ds_read_b128 v[212:215], v34 offset:14336
  v_mul_f32 v113, v113, v48
  v_mfma_f32_16x16x32_bf16 v[120:123], a[68:71], v[208:211], v[120:123]
  buffer_load_dwordx4 v96, s[24:27], s6 offen lds
  v_mul_f32 v114, v114, v48
  v_mfma_f32_16x16x32_bf16 v[120:123], a[84:87], v[220:223], v[120:123]
  ds_read_b128 v[224:227], v34 offset:17408
  v_mul_f32 v115, v115, v48
  s_waitcnt lgkmcnt(7)
  v_mfma_f32_16x16x32_bf16 v[116:119], a[96:99], v[232:235], v[116:119]
  buffer_load_dwordx4 v97, s[24:27], s6 offen offset:1024 lds
  v_cvt_pk_bf16_f32 v62, v112, v113
  s_waitcnt lgkmcnt(6)
  v_mfma_f32_16x16x32_bf16 v[116:119], a[112:115], v[244:247], v[116:119]
  ds_read_b128 v[236:239], v34 offset:20480
  v_cvt_pk_bf16_f32 v63, v114, v115
  v_mfma_f32_16x16x32_bf16 v[120:123], a[100:103], v[232:235], v[120:123]
  buffer_store_dwordx4 v[60:63], v35, s[32:35], s77 offen sc1
  v_mfma_f32_16x16x32_bf16 v[120:123], a[116:119], v[244:247], v[120:123]
  ds_read_b128 v[248:251], v34 offset:23552
  s_waitcnt lgkmcnt(7)
  v_mfma_f32_16x16x32_bf16 v[124:127], a[0:3], v[164:167], 0
  ds_read_b64_tr_b16 a[128:129], v92
  s_waitcnt lgkmcnt(7)
  v_mfma_f32_16x16x32_bf16 v[124:127], a[16:19], v[176:179], v[124:127]
  ds_read_b64_tr_b16 a[130:131], v92 offset:2048
  v_mfma_f32_16x16x32_bf16 v[128:131], a[4:7], v[164:167], 0
  ds_read_b64_tr_b16 a[132:133], v93
  v_mfma_f32_16x16x32_bf16 v[128:131], a[20:23], v[176:179], v[128:131]
  ds_read_b64_tr_b16 a[134:135], v93 offset:2048
  s_waitcnt lgkmcnt(9)
  v_mfma_f32_16x16x32_bf16 v[124:127], a[32:35], v[188:191], v[124:127]
  ds_read_b64_tr_b16 a[136:137], v94
  v_mul_f32 v116, v116, v49
  s_waitcnt lgkmcnt(9)
  v_mfma_f32_16x16x32_bf16 v[124:127], a[48:51], v[200:203], v[124:127]
  ds_read_b64_tr_b16 a[138:139], v94 offset:2048
  v_mul_f32 v117, v117, v49
  v_mfma_f32_16x16x32_bf16 v[128:131], a[36:39], v[188:191], v[128:131]
  ds_read_b64_tr_b16 a[140:141], v95
  v_mul_f32 v118, v118, v49
  v_mfma_f32_16x16x32_bf16 v[128:131], a[52:55], v[200:203], v[128:131]
  ds_read_b64_tr_b16 a[142:143], v95 offset:2048
  v_mul_f32 v119, v119, v49
  s_waitcnt lgkmcnt(11)
  v_mfma_f32_16x16x32_bf16 v[124:127], a[64:67], v[212:215], v[124:127]
  s_waitcnt vmcnt(19)
  buffer_load_dwordx4 v98, s[24:27], s6 offen offset:2048 lds
  v_cvt_pk_bf16_f32 v64, v116, v117
  s_waitcnt lgkmcnt(10)
  v_mfma_f32_16x16x32_bf16 v[124:127], a[80:83], v[224:227], v[124:127]
  buffer_load_dwordx4 v99, s[24:27], s6 offen offset:3072 lds
  v_cvt_pk_bf16_f32 v65, v118, v119
  v_mfma_f32_16x16x32_bf16 v[128:131], a[68:71], v[212:215], v[128:131]
  ds_read_b64_tr_b16 a[144:145], v92 offset:4096
  v_mul_f32 v120, v120, v49
  v_mfma_f32_16x16x32_bf16 v[128:131], a[84:87], v[224:227], v[128:131]
  ds_read_b64_tr_b16 a[146:147], v92 offset:6144
  s_add_u32 m0, s65, 4096
  s_waitcnt lgkmcnt(11)
  v_mfma_f32_16x16x32_bf16 v[124:127], a[96:99], v[236:239], v[124:127]
  ds_read_b64_tr_b16 a[148:149], v93 offset:4096
  v_mul_f32 v121, v121, v49
  s_waitcnt lgkmcnt(11)
  v_mfma_f32_16x16x32_bf16 v[124:127], a[112:115], v[248:251], v[124:127]
  ds_read_b64_tr_b16 a[150:151], v93 offset:6144
  s_add_u32 s6, s83, 200832
  v_mfma_f32_16x16x32_bf16 v[128:131], a[100:103], v[236:239], v[128:131]
  buffer_load_dwordx4 v96, s[24:27], s6 offen lds
  v_mul_f32 v122, v122, v49
  v_mfma_f32_16x16x32_bf16 v[128:131], a[116:119], v[248:251], v[128:131]
  buffer_load_dwordx4 v97, s[24:27], s6 offen offset:1024 lds
  v_mul_f32 v123, v123, v49
  v_mfma_f32_16x16x32_bf16 v[132:135], a[8:11], v[156:159], 0
  buffer_load_dwordx4 v98, s[24:27], s6 offen offset:2048 lds
  v_cvt_pk_bf16_f32 v66, v120, v121
  v_mfma_f32_16x16x32_bf16 v[132:135], a[24:27], v[168:171], v[132:135]
  buffer_load_dwordx4 v99, s[24:27], s6 offen offset:3072 lds
  v_cvt_pk_bf16_f32 v67, v122, v123
  buffer_store_dwordx4 v[64:67], v35, s[32:35], s77 offen offset:1024 sc1
  v_mfma_f32_16x16x32_bf16 v[136:139], a[12:15], v[156:159], 0
  ds_read_b64_tr_b16 a[152:153], v94 offset:4096
  v_mfma_f32_16x16x32_bf16 v[136:139], a[28:31], v[168:171], v[136:139]
  ds_read_b64_tr_b16 a[154:155], v94 offset:6144
  v_mfma_f32_16x16x32_bf16 v[132:135], a[40:43], v[180:183], v[132:135]
  ds_read_b64_tr_b16 a[156:157], v95 offset:4096
  v_mul_f32 v124, v124, v50
  v_mfma_f32_16x16x32_bf16 v[132:135], a[56:59], v[192:195], v[132:135]
  ds_read_b64_tr_b16 a[158:159], v95 offset:6144
  s_waitcnt vmcnt(22)
  v_mul_f32 v125, v125, v50
  v_mfma_f32_16x16x32_bf16 v[136:139], a[44:47], v[180:183], v[136:139]
  ds_read_b64_tr_b16 a[160:161], v92 offset:32768
  v_mul_f32 v126, v126, v50
  v_mfma_f32_16x16x32_bf16 v[136:139], a[60:63], v[192:195], v[136:139]
  ds_read_b64_tr_b16 a[162:163], v92 offset:34816
  v_mul_f32 v127, v127, v50
  v_mfma_f32_16x16x32_bf16 v[132:135], a[72:75], v[204:207], v[132:135]
  ds_read_b64_tr_b16 a[164:165], v93 offset:32768
  v_cvt_pk_bf16_f32 v68, v124, v125
  v_mfma_f32_16x16x32_bf16 v[132:135], a[88:91], v[216:219], v[132:135]
  ds_read_b64_tr_b16 a[166:167], v93 offset:34816
  v_cvt_pk_bf16_f32 v69, v126, v127
  v_mfma_f32_16x16x32_bf16 v[136:139], a[76:79], v[204:207], v[136:139]
  ds_read_b64_tr_b16 a[168:169], v94 offset:32768
  v_mul_f32 v128, v128, v50
  v_mfma_f32_16x16x32_bf16 v[136:139], a[92:95], v[216:219], v[136:139]
  ds_read_b64_tr_b16 a[170:171], v94 offset:34816
  v_mul_f32 v129, v129, v50
  v_mfma_f32_16x16x32_bf16 v[132:135], a[104:107], v[228:231], v[132:135]
  ds_read_b64_tr_b16 a[172:173], v95 offset:32768
  v_mul_f32 v130, v130, v50
  v_mfma_f32_16x16x32_bf16 v[132:135], a[120:123], v[240:243], v[132:135]
  ds_read_b64_tr_b16 a[174:175], v95 offset:34816
  v_mul_f32 v131, v131, v50
  v_mfma_f32_16x16x32_bf16 v[136:139], a[108:111], v[228:231], v[136:139]
  s_waitcnt vmcnt(18)
  ds_read_b64_tr_b16 a[176:177], v92 offset:36864
  v_cvt_pk_bf16_f32 v70, v128, v129
  v_mfma_f32_16x16x32_bf16 v[136:139], a[124:127], v[240:243], v[136:139]
  ds_read_b64_tr_b16 a[178:179], v92 offset:38912
  v_cvt_pk_bf16_f32 v71, v130, v131
  v_mfma_f32_16x16x32_bf16 v[140:143], a[8:11], v[160:163], 0
  buffer_store_dwordx4 v[68:71], v35, s[32:35], s77 offen offset:2048 sc1
  v_mfma_f32_16x16x32_bf16 v[140:143], a[24:27], v[172:175], v[140:143]
  ds_read_b64_tr_b16 a[180:181], v93 offset:36864
  v_mfma_f32_16x16x32_bf16 v[144:147], a[12:15], v[160:163], 0
  ds_read_b64_tr_b16 a[182:183], v93 offset:38912
  v_mfma_f32_16x16x32_bf16 v[144:147], a[28:31], v[172:175], v[144:147]
  ds_read_b64_tr_b16 a[184:185], v94 offset:36864
  s_add_u32 s78, s91, 3072
  v_mfma_f32_16x16x32_bf16 v[140:143], a[40:43], v[184:187], v[140:143]
  ds_read_b64_tr_b16 a[186:187], v94 offset:38912
  v_mul_f32 v132, v132, v48
  v_mfma_f32_16x16x32_bf16 v[140:143], a[56:59], v[196:199], v[140:143]
  ds_read_b64_tr_b16 a[188:189], v95 offset:36864
  v_mul_f32 v133, v133, v48
  v_mfma_f32_16x16x32_bf16 v[144:147], a[44:47], v[184:187], v[144:147]
  ds_read_b64_tr_b16 a[190:191], v95 offset:38912
  v_mul_f32 v134, v134, v48
  v_mfma_f32_16x16x32_bf16 v[144:147], a[60:63], v[196:199], v[144:147]
  v_mul_f32 v135, v135, v48
  v_cvt_pk_bf16_f32 v72, v132, v133
  v_mfma_f32_16x16x32_bf16 v[140:143], a[72:75], v[208:211], v[140:143]
  v_cvt_pk_bf16_f32 v73, v134, v135
  v_mul_f32 v136, v136, v48
  v_mfma_f32_16x16x32_bf16 v[140:143], a[88:91], v[220:223], v[140:143]
  s_waitcnt vmcnt(15)
  ds_read_b64_tr_b16 a[192:193], v25 offset:8192
  v_mul_f32 v137, v137, v48
  v_mfma_f32_16x16x32_bf16 v[144:147], a[76:79], v[208:211], v[144:147]
  ds_read_b64_tr_b16 a[194:195], v25 offset:10240
  v_mul_f32 v138, v138, v48
  v_mfma_f32_16x16x32_bf16 v[144:147], a[92:95], v[220:223], v[144:147]
  ds_read_b64_tr_b16 a[196:197], v26 offset:8192
  v_mul_f32 v139, v139, v48
  v_mfma_f32_16x16x32_bf16 v[140:143], a[104:107], v[232:235], v[140:143]
  ds_read_b64_tr_b16 a[198:199], v26 offset:10240
  v_cvt_pk_bf16_f32 v74, v136, v137
  v_mfma_f32_16x16x32_bf16 v[140:143], a[120:123], v[244:247], v[140:143]
  ds_read_b64_tr_b16 a[200:201], v27 offset:8192
  v_cvt_pk_bf16_f32 v75, v138, v139
  v_mfma_f32_16x16x32_bf16 v[144:147], a[108:111], v[232:235], v[144:147]
  buffer_store_dwordx4 v[72:75], v35, s[32:35], s78 offen sc1
  v_mfma_f32_16x16x32_bf16 v[144:147], a[124:127], v[244:247], v[144:147]
  ds_read_b64_tr_b16 a[202:203], v27 offset:10240
  v_mfma_f32_16x16x32_bf16 v[148:151], a[8:11], v[164:167], 0
  ds_read_b64_tr_b16 a[204:205], v28 offset:8192
  v_mfma_f32_16x16x32_bf16 v[148:151], a[24:27], v[176:179], v[148:151]
  ds_read_b64_tr_b16 a[206:207], v28 offset:10240
  v_mfma_f32_16x16x32_bf16 v[152:155], a[12:15], v[164:167], 0
  v_mfma_f32_16x16x32_bf16 v[152:155], a[28:31], v[176:179], v[152:155]
  v_mfma_f32_16x16x32_bf16 v[148:151], a[40:43], v[188:191], v[148:151]
  s_waitcnt vmcnt(12)
  ds_read_b64_tr_b16 a[208:209], v25 offset:12288
  v_mul_f32 v140, v140, v49
  v_mfma_f32_16x16x32_bf16 v[148:151], a[56:59], v[200:203], v[148:151]
  ds_read_b64_tr_b16 a[210:211], v25 offset:14336
  v_mul_f32 v141, v141, v49
  v_mfma_f32_16x16x32_bf16 v[152:155], a[44:47], v[188:191], v[152:155]
  ds_read_b64_tr_b16 a[212:213], v26 offset:12288
  v_mul_f32 v142, v142, v49
  v_mfma_f32_16x16x32_bf16 v[152:155], a[60:63], v[200:203], v[152:155]
  ds_read_b64_tr_b16 a[214:215], v26 offset:14336
  v_mul_f32 v143, v143, v49
  v_mfma_f32_16x16x32_bf16 v[148:151], a[72:75], v[212:215], v[148:151]
  ds_read_b64_tr_b16 a[216:217], v27 offset:12288
  v_cvt_pk_bf16_f32 v76, v140, v141
  v_mfma_f32_16x16x32_bf16 v[148:151], a[88:91], v[224:227], v[148:151]
  ds_read_b64_tr_b16 a[218:219], v27 offset:14336
  v_cvt_pk_bf16_f32 v77, v142, v143
  v_mfma_f32_16x16x32_bf16 v[152:155], a[76:79], v[212:215], v[152:155]
  ds_read_b64_tr_b16 a[220:221], v28 offset:12288
  v_mul_f32 v144, v144, v49
  v_mfma_f32_16x16x32_bf16 v[152:155], a[92:95], v[224:227], v[152:155]
  ds_read_b64_tr_b16 a[222:223], v28 offset:14336
  v_mul_f32 v145, v145, v49
  v_mfma_f32_16x16x32_bf16 v[148:151], a[104:107], v[236:239], v[148:151]
  v_mul_f32 v146, v146, v49
  v_mul_f32 v147, v147, v49
  v_mfma_f32_16x16x32_bf16 v[148:151], a[120:123], v[248:251], v[148:151]
  v_cvt_pk_bf16_f32 v78, v144, v145
  v_cvt_pk_bf16_f32 v79, v146, v147
  v_mfma_f32_16x16x32_bf16 v[152:155], a[108:111], v[236:239], v[152:155]
  buffer_store_dwordx4 v[76:79], v35, s[32:35], s78 offen offset:1024 sc1
  v_mfma_f32_16x16x32_bf16 v[152:155], a[124:127], v[248:251], v[152:155]
  s_waitcnt vmcnt(8)
  ds_read_b64_tr_b16 a[224:225], v25
  s_waitcnt lgkmcnt(15)
  v_mfma_f32_16x16x32_bf16 v[108:111], a[128:131], v[156:159], 0
  ds_read_b64_tr_b16 a[226:227], v25 offset:2048
  v_mfma_f32_16x16x32_bf16 v[108:111], a[144:147], v[168:171], v[108:111]
  ds_read_b64_tr_b16 a[228:229], v26
  v_mfma_f32_16x16x32_bf16 v[116:119], a[128:131], v[160:163], 0
  ds_read_b64_tr_b16 a[230:231], v26 offset:2048
  v_mfma_f32_16x16x32_bf16 v[116:119], a[144:147], v[172:175], v[116:119]
  ds_read_b64_tr_b16 a[232:233], v27
  v_mfma_f32_16x16x32_bf16 v[124:127], a[128:131], v[164:167], 0
  ds_read_b64_tr_b16 a[234:235], v27 offset:2048
  v_mul_f32 v148, v148, v50
  v_mfma_f32_16x16x32_bf16 v[124:127], a[144:147], v[176:179], v[124:127]
  ds_read_b64_tr_b16 a[236:237], v28
  v_mul_f32 v149, v149, v50
  v_mfma_f32_16x16x32_bf16 v[112:115], a[132:135], v[156:159], 0
  ds_read_b64_tr_b16 a[238:239], v28 offset:2048
  v_mul_f32 v150, v150, v50
  v_mfma_f32_16x16x32_bf16 v[112:115], a[148:151], v[168:171], v[112:115]
  v_mul_f32 v151, v151, v50
  v_cvt_pk_bf16_f32 v80, v148, v149
  v_mfma_f32_16x16x32_bf16 v[120:123], a[132:135], v[160:163], 0
  v_cvt_pk_bf16_f32 v81, v150, v151
  v_mul_f32 v152, v152, v50
  v_mfma_f32_16x16x32_bf16 v[120:123], a[148:151], v[172:175], v[120:123]
  v_mul_f32 v153, v153, v50
  v_mul_f32 v154, v154, v50
  v_mfma_f32_16x16x32_bf16 v[128:131], a[132:135], v[164:167], 0
  s_waitcnt vmcnt(4)
  ds_read_b64_tr_b16 a[240:241], v25 offset:4096
  v_mul_f32 v155, v155, v50
  v_mfma_f32_16x16x32_bf16 v[128:131], a[148:151], v[176:179], v[128:131]
  ds_read_b64_tr_b16 a[242:243], v25 offset:6144
  v_cvt_pk_bf16_f32 v82, v152, v153
  v_mfma_f32_16x16x32_bf16 v[108:111], a[160:163], v[180:183], v[108:111]
  ds_read_b64_tr_b16 a[244:245], v26 offset:4096
  v_cvt_pk_bf16_f32 v83, v154, v155
  v_mfma_f32_16x16x32_bf16 v[108:111], a[176:179], v[192:195], v[108:111]
  buffer_store_dwordx4 v[80:83], v35, s[32:35], s78 offen offset:2048 sc1
  v_mfma_f32_16x16x32_bf16 v[116:119], a[160:163], v[184:187], v[116:119]
  ds_read_b64_tr_b16 a[246:247], v26 offset:6144
  v_mfma_f32_16x16x32_bf16 v[116:119], a[176:179], v[196:199], v[116:119]
L_it6:
  s_cbranch_execz L_it10
  ds_read_b64_tr_b16 a[248:249], v27 offset:4096
  v_mfma_f32_16x16x32_bf16 v[124:127], a[160:163], v[188:191], v[124:127]
  ds_read_b64_tr_b16 a[250:251], v27 offset:6144
  v_mfma_f32_16x16x32_bf16 v[124:127], a[176:179], v[200:203], v[124:127]
  ds_read_b64_tr_b16 a[252:253], v28 offset:4096
  v_mfma_f32_16x16x32_bf16 v[112:115], a[164:167], v[180:183], v[112:115]
  ds_read_b64_tr_b16 a[254:255], v28 offset:6144
  v_mfma_f32_16x16x32_bf16 v[112:115], a[180:183], v[192:195], v[112:115]
  v_mfma_f32_16x16x32_bf16 v[120:123], a[164:167], v[184:187], v[120:123]
  v_mfma_f32_16x16x32_bf16 v[120:123], a[180:183], v[196:199], v[120:123]
  v_mfma_f32_16x16x32_bf16 v[128:131], a[164:167], v[188:191], v[128:131]
  v_mfma_f32_16x16x32_bf16 v[128:131], a[180:183], v[200:203], v[128:131]
  v_mfma_f32_16x16x32_bf16 v[108:111], a[192:195], v[204:207], v[108:111]
  s_waitcnt lgkmcnt(15)
  v_mfma_f32_16x16x32_bf16 v[108:111], a[208:211], v[216:219], v[108:111]
  v_mfma_f32_16x16x32_bf16 v[116:119], a[192:195], v[208:211], v[116:119]
  v_mfma_f32_16x16x32_bf16 v[116:119], a[208:211], v[220:223], v[116:119]
  v_mfma_f32_16x16x32_bf16 v[124:127], a[192:195], v[212:215], v[124:127]
  v_mfma_f32_16x16x32_bf16 v[124:127], a[208:211], v[224:227], v[124:127]
  v_mfma_f32_16x16x32_bf16 v[112:115], a[196:199], v[204:207], v[112:115]
  v_mfma_f32_16x16x32_bf16 v[112:115], a[212:215], v[216:219], v[112:115]
  v_mfma_f32_16x16x32_bf16 v[120:123], a[196:199], v[208:211], v[120:123]
  v_mfma_f32_16x16x32_bf16 v[120:123], a[212:215], v[220:223], v[120:123]
  v_mfma_f32_16x16x32_bf16 v[128:131], a[196:199], v[212:215], v[128:131]
  v_mfma_f32_16x16x32_bf16 v[128:131], a[212:215], v[224:227], v[128:131]
  s_waitcnt lgkmcnt(14)
  v_mfma_f32_16x16x32_bf16 v[108:111], a[224:227], v[228:231], v[108:111]
  s_waitcnt lgkmcnt(6)
  v_mfma_f32_16x16x32_bf16 v[108:111], a[240:243], v[240:243], v[108:111]
  v_mfma_f32_16x16x32_bf16 v[116:119], a[224:227], v[232:235], v[116:119]
  v_mfma_f32_16x16x32_bf16 v[116:119], a[240:243], v[244:247], v[116:119]
  v_mfma_f32_16x16x32_bf16 v[124:127], a[224:227], v[236:239], v[124:127]
  v_mfma_f32_16x16x32_bf16 v[124:127], a[240:243], v[248:251], v[124:127]
  v_mfma_f32_16x16x32_bf16 v[112:115], a[228:231], v[228:231], v[112:115]
  s_waitcnt lgkmcnt(4)
  v_mfma_f32_16x16x32_bf16 v[112:115], a[244:247], v[240:243], v[112:115]
  v_mfma_f32_16x16x32_bf16 v[120:123], a[228:231], v[232:235], v[120:123]
  v_mfma_f32_16x16x32_bf16 v[120:123], a[244:247], v[244:247], v[120:123]
  v_mfma_f32_16x16x32_bf16 v[128:131], a[228:231], v[236:239], v[128:131]
  v_mfma_f32_16x16x32_bf16 v[128:131], a[244:247], v[248:251], v[128:131]
  v_mfma_f32_16x16x32_bf16 v[132:135], a[136:139], v[156:159], 0
  v_mfma_f32_16x16x32_bf16 v[132:135], a[152:155], v[168:171], v[132:135]
  v_mfma_f32_16x16x32_bf16 v[136:139], a[140:143], v[156:159], 0
  v_mfma_f32_16x16x32_bf16 v[136:139], a[156:159], v[168:171], v[136:139]
  s_add_u32 s77, s91, 6144
  v_mfma_f32_16x16x32_bf16 v[132:135], a[168:171], v[180:183], v[132:135]
  v_mul_f32 v108, v108, v48
  v_mul_f32 v109, v109, v48
  v_mfma_f32_16x16x32_bf16 v[132:135], a[184:187], v[192:195], v[132:135]
  v_mul_f32 v110, v110, v48
  v_mul_f32 v111, v111, v48
  v_mfma_f32_16x16x32_bf16 v[136:139], a[172:175], v[180:183], v[136:139]
  v_cvt_pk_bf16_f32 v60, v108, v109
  v_cvt_pk_bf16_f32 v61, v110, v111
  v_mfma_f32_16x16x32_bf16 v[136:139], a[188:191], v[192:195], v[136:139]
  v_mul_f32 v112, v112, v48
  v_mul_f32 v113, v113, v48
  v_mfma_f32_16x16x32_bf16 v[132:135], a[200:203], v[204:207], v[132:135]
  v_mul_f32 v114, v114, v48
  v_mul_f32 v115, v115, v48
  v_mfma_f32_16x16x32_bf16 v[132:135], a[216:219], v[216:219], v[132:135]
  v_cvt_pk_bf16_f32 v62, v112, v113
  v_cvt_pk_bf16_f32 v63, v114, v115
  v_mfma_f32_16x16x32_bf16 v[136:139], a[204:207], v[204:207], v[136:139]
  buffer_store_dwordx4 v[60:63], v35, s[32:35], s77 offen sc1
  v_mfma_f32_16x16x32_bf16 v[136:139], a[220:223], v[216:219], v[136:139]
  v_mul_f32 v116, v116, v49
  v_mul_f32 v117, v117, v49
  v_mfma_f32_16x16x32_bf16 v[132:135], a[232:235], v[228:231], v[132:135]
  v_mul_f32 v118, v118, v49
  v_mul_f32 v119, v119, v49
  s_waitcnt lgkmcnt(2)
  v_mfma_f32_16x16x32_bf16 v[132:135], a[248:251], v[240:243], v[132:135]
  v_cvt_pk_bf16_f32 v64, v116, v117
  v_cvt_pk_bf16_f32 v65, v118, v119
  v_mfma_f32_16x16x32_bf16 v[136:139], a[236:239], v[228:231], v[136:139]
  v_mul_f32 v120, v120, v49
  v_mul_f32 v121, v121, v49
  s_waitcnt lgkmcnt(0)
  v_mfma_f32_16x16x32_bf16 v[136:139], a[252:255], v[240:243], v[136:139]
  v_mul_f32 v122, v122, v49
  v_mul_f32 v123, v123, v49
  v_mfma_f32_16x16x32_bf16 v[140:143], a[136:139], v[160:163], 0
  v_cvt_pk_bf16_f32 v66, v120, v121
  v_cvt_pk_bf16_f32 v67, v122, v123
  v_mfma_f32_16x16x32_bf16 v[140:143], a[152:155], v[172:175], v[140:143]
  buffer_store_dwordx4 v[64:67], v35, s[32:35], s77 offen offset:1024 sc1
  v_mfma_f32_16x16x32_bf16 v[144:147], a[140:143], v[160:163], 0
  v_mul_f32 v124, v124, v50
  v_mul_f32 v125, v125, v50
  v_mfma_f32_16x16x32_bf16 v[144:147], a[156:159], v[172:175], v[144:147]
  s_add_u32 s78, s91, 9216
  v_mul_f32 v126, v126, v50
  v_mul_f32 v127, v127, v50
  v_mfma_f32_16x16x32_bf16 v[140:143], a[168:171], v[184:187], v[140:143]
  v_cvt_pk_bf16_f32 v68, v124, v125
  v_cvt_pk_bf16_f32 v69, v126, v127
  v_mfma_f32_16x16x32_bf16 v[140:143], a[184:187], v[196:199], v[140:143]
  s_lshl_b32 s70, 1, s61
  s_mov_b32 s95, s90
  s_add_u32 s90, s90, 128
  v_mfma_f32_16x16x32_bf16 v[144:147], a[172:175], v[184:187], v[144:147]
  s_waitcnt vmcnt(2)
  s_atomic_or s70, s[54:55], s95
  v_mul_f32 v128, v128, v50
  v_mul_f32 v129, v129, v50
  v_mfma_f32_16x16x32_bf16 v[144:147], a[188:191], v[196:199], v[144:147]
  v_mul_f32 v130, v130, v50
  v_mul_f32 v131, v131, v50
  v_mfma_f32_16x16x32_bf16 v[140:143], a[200:203], v[208:211], v[140:143]
  v_cvt_pk_bf16_f32 v70, v128, v129
  v_cvt_pk_bf16_f32 v71, v130, v131
  v_mfma_f32_16x16x32_bf16 v[140:143], a[216:219], v[220:223], v[140:143]
  buffer_store_dwordx4 v[68:71], v35, s[32:35], s77 offen offset:2048 sc1
  v_mfma_f32_16x16x32_bf16 v[144:147], a[204:207], v[208:211], v[144:147]
  v_mul_f32 v132, v132, v48
  v_mul_f32 v133, v133, v48
  v_mfma_f32_16x16x32_bf16 v[144:147], a[220:223], v[220:223], v[144:147]
  v_mul_f32 v134, v134, v48
  v_mul_f32 v135, v135, v48
  v_mfma_f32_16x16x32_bf16 v[140:143], a[232:235], v[232:235], v[140:143]
  v_cvt_pk_bf16_f32 v72, v132, v133
  v_cvt_pk_bf16_f32 v73, v134, v135
  v_mfma_f32_16x16x32_bf16 v[140:143], a[248:251], v[244:247], v[140:143]
  v_mul_f32 v136, v136, v48
  v_mul_f32 v137, v137, v48
  v_mfma_f32_16x16x32_bf16 v[144:147], a[236:239], v[232:235], v[144:147]
  v_mul_f32 v138, v138, v48
  v_mul_f32 v139, v139, v48
  v_mfma_f32_16x16x32_bf16 v[144:147], a[252:255], v[244:247], v[144:147]
  v_cvt_pk_bf16_f32 v74, v136, v137
  v_cvt_pk_bf16_f32 v75, v138, v139
  v_mfma_f32_16x16x32_bf16 v[148:151], a[136:139], v[164:167], 0
  buffer_store_dwordx4 v[72:75], v35, s[32:35], s78 offen sc1
  v_mfma_f32_16x16x32_bf16 v[148:151], a[152:155], v[176:179], v[148:151]
  v_mfma_f32_16x16x32_bf16 v[152:155], a[140:143], v[164:167], 0
  v_mfma_f32_16x16x32_bf16 v[152:155], a[156:159], v[176:179], v[152:155]
  v_mfma_f32_16x16x32_bf16 v[148:151], a[168:171], v[188:191], v[148:151]
  v_mul_f32 v140, v140, v49
  v_mul_f32 v141, v141, v49
  v_mfma_f32_16x16x32_bf16 v[148:151], a[184:187], v[200:203], v[148:151]
  v_mul_f32 v142, v142, v49
  v_mul_f32 v143, v143, v49
  v_mfma_f32_16x16x32_bf16 v[152:155], a[172:175], v[188:191], v[152:155]
  v_cvt_pk_bf16_f32 v76, v140, v141
  v_cvt_pk_bf16_f32 v77, v142, v143
  v_mfma_f32_16x16x32_bf16 v[152:155], a[188:191], v[200:203], v[152:155]
  v_mul_f32 v144, v144, v49
  v_mul_f32 v145, v145, v49
  v_mfma_f32_16x16x32_bf16 v[148:151], a[200:203], v[212:215], v[148:151]
  v_mul_f32 v146, v146, v49
  v_mul_f32 v147, v147, v49
  v_mfma_f32_16x16x32_bf16 v[148:151], a[216:219], v[224:227], v[148:151]
  v_cvt_pk_bf16_f32 v78, v144, v145
  v_cvt_pk_bf16_f32 v79, v146, v147
  v_mfma_f32_16x16x32_bf16 v[152:155], a[204:207], v[212:215], v[152:155]
  buffer_store_dwordx4 v[76:79], v35, s[32:35], s78 offen offset:1024 sc1
  v_mfma_f32_16x16x32_bf16 v[152:155], a[220:223], v[224:227], v[152:155]
  v_mfma_f32_16x16x32_bf16 v[148:151], a[232:235], v[236:239], v[148:151]
  v_mfma_f32_16x16x32_bf16 v[148:151], a[248:251], v[248:251], v[148:151]
  v_mfma_f32_16x16x32_bf16 v[152:155], a[236:239], v[236:239], v[152:155]
  v_mfma_f32_16x16x32_bf16 v[152:155], a[252:255], v[248:251], v[152:155]
  s_nop 5
  v_mul_f32 v148, v148, v50
  v_mul_f32 v149, v149, v50
  v_mul_f32 v150, v150, v50
  v_mul_f32 v151, v151, v50
  v_cvt_pk_bf16_f32 v80, v148, v149
  v_cvt_pk_bf16_f32 v81, v150, v151
  v_mul_f32 v152, v152, v50
  v_mul_f32 v153, v153, v50
  v_mul_f32 v154, v154, v50
  v_mul_f32 v155, v155, v50
  v_cvt_pk_bf16_f32 v82, v152, v153
  v_cvt_pk_bf16_f32 v83, v154, v155
  buffer_store_dwordx4 v[80:83], v35, s[32:35], s78 offen offset:2048 sc1
L_opdone:
L_it7:
  s_cbranch_execz L_it11
  s_load_dword s79, s[54:55], s40 glc
  s_lshl_b32 s5, 1, s61
  s_mov_b32 s68, 0
  s_mov_b32 s4, 0
  s_mov_b32 s71, 0
  v_add_u32 v44, 43008, v100
  v_add_u32 v45, 86016, v100
  v_add_u32 v46, 129024, v100
  s_add_u32 s72, s92, 0
  s_add_u32 s73, s92, 172032
  s_add_u32 s74, s92, 344064
  s_add_u32 s75, s92, 516096
  s_waitcnt vmcnt(0)
  s_waitcnt lgkmcnt(0)
  s_atomic_or s5, s[54:55], s90
  s_cmp_lg_u32 s7, 0
  s_cbranch_scc1 L_done
L_round:
  s_or_b32 s67, s79, s79
  s_lshr_b32 s81, s67, 1
  s_and_b32 s67, s67, s81
  s_lshr_b32 s81, s67, 2
  s_and_b32 s67, s67, s81
  s_and_b32 s67, s67, 0x1111
  s_andn2_b32 s69, s67, s68
  s_cmp_lg_u32 s69, 0x1111
  s_cbranch_scc1 L_partial
  buffer_load_dwordx4 v[156:159], v100, s[32:35], s72 offen sc1 nt
  buffer_load_dwordx4 v[160:163], v44, s[32:35], s72 offen sc1 nt
  buffer_load_dwordx4 v[164:167], v45, s[32:35], s72 offen sc1 nt
  buffer_load_dwordx4 v[168:171], v46, s[32:35], s72 offen sc1 nt
  buffer_load_dwordx4 v[172:175], v100, s[32:35], s73 offen sc1 nt
  buffer_load_dwordx4 v[176:179], v44, s[32:35], s73 offen sc1 nt
  buffer_load_dwordx4 v[180:183], v45, s[32:35], s73 offen sc1 nt
  buffer_load_dwordx4 v[184:187], v46, s[32:35], s73 offen sc1 nt
  buffer_load_dwordx4 v[188:191], v100, s[32:35], s74 offen sc1 nt
  buffer_load_dwordx4 v[192:195], v44, s[32:35], s74 offen sc1 nt
  buffer_load_dwordx4 v[196:199], v45, s[32:35], s74 offen sc1 nt
  buffer_load_dwordx4 v[200:203], v46, s[32:35], s74 offen sc1 nt
  buffer_load_dwordx4 v[204:207], v100, s[32:35], s75 offen sc1 nt
  buffer_load_dwordx4 v[208:211], v44, s[32:35], s75 offen sc1 nt
  buffer_load_dwordx4 v[212:215], v45, s[32:35], s75 offen sc1 nt
  buffer_load_dwordx4 v[216:219], v46, s[32:35], s75 offen sc1 nt
  s_waitcnt vmcnt(15)
  v_mfma_f32_16x16x32_bf16 v[108:111], v[86:89], v[156:159], 0
  v_mfma_f32_16x16x32_bf16 v[112:115], v[84:87], v[156:159], 0
  s_waitcnt vmcnt(14)
  v_mfma_f32_16x16x32_bf16 v[108:111], v[86:89], v[160:163], v[108:111]
  v_mfma_f32_16x16x32_bf16 v[112:115], v[84:87], v[160:163], v[112:115]
  s_waitcnt vmcnt(13)
  v_mfma_f32_16x16x32_bf16 v[108:111], v[86:89], v[164:167], v[108:111]
  v_mfma_f32_16x16x32_bf16 v[112:115], v[84:87], v[164:167], v[112:115]
  s_waitcnt vmcnt(12)
  v_mfma_f32_16x16x32_bf16 v[108:111], v[86:89], v[168:171], v[108:111]
  v_mfma_f32_16x16x32_bf16 v[112:115], v[84:87], v[168:171], v[112:115]
  s_waitcnt vmcnt(11)
  v_mfma_f32_16x16x32_bf16 v[116:119], v[86:89], v[172:175], 0
  v_mfma_f32_16x16x32_bf16 v[120:123], v[84:87], v[172:175], 0
  s_waitcnt vmcnt(10)
  v_mfma_f32_16x16x32_bf16 v[116:119], v[86:89], v[176:179], v[116:119]
  v_mfma_f32_16x16x32_bf16 v[120:123], v[84:87], v[176:179], v[120:123]
  s_waitcnt vmcnt(9)
  v_mfma_f32_16x16x32_bf16 v[116:119], v[86:89], v[180:183], v[116:119]
  v_mfma_f32_16x16x32_bf16 v[120:123], v[84:87], v[180:183], v[120:123]
  s_waitcnt vmcnt(8)
  v_mfma_f32_16x16x32_bf16 v[116:119], v[86:89], v[184:187], v[116:119]
  v_mfma_f32_16x16x32_bf16 v[120:123], v[84:87], v[184:187], v[120:123]
  s_waitcnt vmcnt(7)
  v_mfma_f32_16x16x32_bf16 v[124:127], v[86:89], v[188:191], 0
  v_mfma_f32_16x16x32_bf16 v[128:131], v[84:87], v[188:191], 0
  s_waitcnt vmcnt(6)
  v_mfma_f32_16x16x32_bf16 v[124:127], v[86:89], v[192:195], v[124:127]
  v_mfma_f32_16x16x32_bf16 v[128:131], v[84:87], v[192:195], v[128:131]
  s_waitcnt vmcnt(5)
  v_mfma_f32_16x16x32_bf16 v[124:127], v[86:89], v[196:199], v[124:127]
  v_mfma_f32_16x16x32_bf16 v[128:131], v[84:87], v[196:199], v[128:131]
  s_waitcnt vmcnt(4)
  v_mfma_f32_16x16x32_bf16 v[124:127], v[86:89], v[200:203], v[124:127]
  v_mfma_f32_16x16x32_bf16 v[128:131], v[84:87], v[200:203], v[128:131]
  s_waitcnt vmcnt(3)
  v_mfma_f32_16x16x32_bf16 v[132:135], v[86:89], v[204:207], 0
  v_mfma_f32_16x16x32_bf16 v[136:139], v[84:87], v[204:207], 0
  s_waitcnt vmcnt(2)
  v_mfma_f32_16x16x32_bf16 v[132:135], v[86:89], v[208:211], v[132:135]
  v_mfma_f32_16x16x32_bf16 v[136:139], v[84:87], v[208:211], v[136:139]
  s_waitcnt vmcnt(1)
  v_mfma_f32_16x16x32_bf16 v[132:135], v[86:89], v[212:215], v[132:135]
  v_mfma_f32_16x16x32_bf16 v[136:139], v[84:87], v[212:215], v[136:139]
  s_waitcnt vmcnt(0)
  v_mfma_f32_16x16x32_bf16 v[132:135], v[86:89], v[216:219], v[132:135]
  v_mfma_f32_16x16x32_bf16 v[136:139], v[84:87], v[216:219], v[136:139]
L_final:
L_it8:
  s_cbranch_execz L_it12
  s_nop 7
  v_add_f32 v108, v108, v116
  v_add_f32 v124, v124, v132
  v_add_f32 v109, v109, v117
  v_add_f32 v125, v125, v133
  v_add_f32 v110, v110, v118
  v_add_f32 v126, v126, v134
  v_add_f32 v111, v111, v119
  v_add_f32 v127, v127, v135
  v_add_f32 v112, v112, v120
  v_add_f32 v128, v128, v136
  v_add_f32 v113, v113, v121
  v_add_f32 v129, v129, v137
  v_add_f32 v114, v114, v122
  v_add_f32 v130, v130, v138
  v_add_f32 v115, v115, v123
  v_add_f32 v131, v131, v139
  v_add_f32 v108, v108, v124
  v_add_f32 v109, v109, v125
  v_add_f32 v110, v110, v126
  v_add_f32 v111, v111, v127
  v_add_f32 v112, v112, v128
  v_add_f32 v113, v113, v129
  v_add_f32 v114, v114, v130
  v_add_f32 v115, v115, v131
  v_cvt_pk_bf16_f32 v116, v108, v109
  v_cvt_pk_bf16_f32 v117, v110, v111
  v_cvt_pk_bf16_f32 v118, v112, v113
  v_cvt_pk_bf16_f32 v119, v114, v115
  ds_write_b64 v102, v[116:117]
  ds_write_b64 v102, v[118:119] offset:32
  ds_read_b128 v[108:111], v103
  s_waitcnt lgkmcnt(0)
  buffer_store_dwordx4 v[108:111], v101, s[28:31], 0 offen
L_done:
L_end:
  s_endpgm
L_it9:
  s_branch L_it13
L_partial:
  s_bitcmp1_b32 s69, 0
  s_cbranch_scc0 L_pl0
  buffer_load_dwordx4 v[156:159], v100, s[32:35], s72 offen sc1 nt
  buffer_load_dwordx4 v[160:163], v44, s[32:35], s72 offen sc1 nt
  buffer_load_dwordx4 v[164:167], v45, s[32:35], s72 offen sc1 nt
  buffer_load_dwordx4 v[168:171], v46, s[32:35], s72 offen sc1 nt
L_pl0:
  s_bitcmp1_b32 s69, 4
  s_cbranch_scc0 L_pl1
  buffer_load_dwordx4 v[172:175], v100, s[32:35], s73 offen sc1 nt
  buffer_load_dwordx4 v[176:179], v44, s[32:35], s73 offen sc1 nt
  buffer_load_dwordx4 v[180:183], v45, s[32:35], s73 offen sc1 nt
  buffer_load_dwordx4 v[184:187], v46, s[32:35], s73 offen sc1 nt
L_pl1:
  s_bitcmp1_b32 s69, 8
  s_cbranch_scc0 L_pl2
  buffer_load_dwordx4 v[188:191], v100, s[32:35], s74 offen sc1 nt
  buffer_load_dwordx4 v[192:195], v44, s[32:35], s74 offen sc1 nt
  buffer_load_dwordx4 v[196:199], v45, s[32:35], s74 offen sc1 nt
  buffer_load_dwordx4 v[200:203], v46, s[32:35], s74 offen sc1 nt
L_pl2:
  s_bitcmp1_b32 s69, 12
  s_cbranch_scc0 L_pl3
  buffer_load_dwordx4 v[204:207], v100, s[32:35], s75 offen sc1 nt
  buffer_load_dwordx4 v[208:211], v44, s[32:35], s75 offen sc1 nt
  buffer_load_dwordx4 v[212:215], v45, s[32:35], s75 offen sc1 nt
  buffer_load_dwordx4 v[216:219], v46, s[32:35], s75 offen sc1 nt
L_pl3:
  s_or_b32 s68, s68, s69
  s_load_dword s79, s[54:55], s40 glc
L_pagain:
  s_cmp_eq_u32 s71, 0
  s_cbranch_scc1 L_pnos
  s_bcnt1_i32_b32 s81, s69
  s_waitcnt vmcnt(12)
  s_cmp_eq_u32 s81, 3
  s_cbranch_scc1 L_pok
  s_waitcnt vmcnt(8)
  s_cmp_eq_u32 s81, 2
  s_cbranch_scc1 L_pok
  s_waitcnt vmcnt(4)
  s_cmp_eq_u32 s81, 1
  s_cbranch_scc1 L_pok
  s_waitcnt vmcnt(0)
L_pok:
  s_bitcmp1_b32 s71, 0
  s_cbranch_scc0 L_ps0
  v_mfma_f32_16x16x32_bf16 v[108:111], v[86:89], v[156:159], 0
  v_mfma_f32_16x16x32_bf16 v[112:115], v[84:87], v[156:159], 0
  v_mfma_f32_16x16x32_bf16 v[108:111], v[86:89], v[160:163], v[108:111]
  v_mfma_f32_16x16x32_bf16 v[112:115], v[84:87], v[160:163], v[112:115]
  v_mfma_f32_16x16x32_bf16 v[108:111], v[86:89], v[164:167], v[108:111]
  v_mfma_f32_16x16x32_bf16 v[112:115], v[84:87], v[164:167], v[112:115]
  v_mfma_f32_16x16x32_bf16 v[108:111], v[86:89], v[168:171], v[108:111]
  v_mfma_f32_16x16x32_bf16 v[112:115], v[84:87], v[168:171], v[112:115]
L_ps0:
  s_bitcmp1_b32 s71, 4
  s_cbranch_scc0 L_ps1
  v_mfma_f32_16x16x32_bf16 v[116:119], v[86:89], v[172:175], 0
  v_mfma_f32_16x16x32_bf16 v[120:123], v[84:87], v[172:175], 0
  v_mfma_f32_16x16x32_bf16 v[116:119], v[86:89], v[176:179], v[116:119]
  v_mfma_f32_16x16x32_bf16 v[120:123], v[84:87], v[176:179], v[120:123]
  v_mfma_f32_16x16x32_bf16 v[116:119], v[86:89], v[180:183], v[116:119]
  v_mfma_f32_16x16x32_bf16 v[120:123], v[84:87], v[180:183], v[120:123]
  v_mfma_f32_16x16x32_bf16 v[116:119], v[86:89], v[184:187], v[116:119]
  v_mfma_f32_16x16x32_bf16 v[120:123], v[84:87], v[184:187], v[120:123]
L_ps1:
  s_bitcmp1_b32 s71, 8
  s_cbranch_scc0 L_ps2
  v_mfma_f32_16x16x32_bf16 v[124:127], v[86:89], v[188:191], 0
  v_mfma_f32_16x16x32_bf16 v[128:131], v[84:87], v[188:191], 0
  v_mfma_f32_16x16x32_bf16 v[124:127], v[86:89], v[192:195], v[124:127]
  v_mfma_f32_16x16x32_bf16 v[128:131], v[84:87], v[192:195], v[128:131]
  v_mfma_f32_16x16x32_bf16 v[124:127], v[86:89], v[196:199], v[124:127]
  v_mfma_f32_16x16x32_bf16 v[128:131], v[84:87], v[196:199], v[128:131]
  v_mfma_f32_16x16x32_bf16 v[124:127], v[86:89], v[200:203], v[124:127]
  v_mfma_f32_16x16x32_bf16 v[128:131], v[84:87], v[200:203], v[128:131]
L_ps2:
  s_bitcmp1_b32 s71, 12
  s_cbranch_scc0 L_ps3
  v_mfma_f32_16x16x32_bf16 v[132:135], v[86:89], v[204:207], 0
  v_mfma_f32_16x16x32_bf16 v[136:139], v[84:87], v[204:207], 0
  v_mfma_f32_16x16x32_bf16 v[132:135], v[86:89], v[208:211], v[132:135]
  v_mfma_f32_16x16x32_bf16 v[136:139], v[84:87], v[208:211], v[136:139]
  v_mfma_f32_16x16x32_bf16 v[132:135], v[86:89], v[212:215], v[132:135]
  v_mfma_f32_16x16x32_bf16 v[136:139], v[84:87], v[212:215], v[136:139]
  v_mfma_f32_16x16x32_bf16 v[132:135], v[86:89], v[216:219], v[132:135]
  v_mfma_f32_16x16x32_bf16 v[136:139], v[84:87], v[216:219], v[136:139]
L_ps3:
L_pnos:
  s_mov_b32 s71, s69
  s_cmp_lg_u32 s68, 0x1111
  s_cbranch_scc1 L_pwait
  s_mov_b32 s69, 0
  s_cmp_lg_u32 s71, 0
  s_cbranch_scc1 L_pagain
  s_branch L_final
L_pwait:
  s_add_u32 s4, s4, 1
  s_waitcnt lgkmcnt(0)
  s_cmp_lt_u32 s4, 0x100000
  s_cbranch_scc1 L_round
  s_branch L_final
L_it10:
  s_branch L_itback
L_poll1:
  s_mov_b32 s4, 0
L_poll1_l:
  s_load_dword s82, s[54:55], s89 glc
  s_add_u32 s4, s4, 1
  s_waitcnt lgkmcnt(0)
  s_cmp_gt_u32 s4, 0x400000
  s_cbranch_scc1 L_poll1x
  s_cmp_eq_u32 s82, 0
  s_cbranch_scc1 L_poll1_l
  s_branch L_poll1x
L_it11:
  s_branch L_itback
L_poll1w:
  s_mov_b32 s4, 0
L_poll1w_l:
  s_load_dword s82, s[54:55], s89 glc
  s_add_u32 s4, s4, 1
  s_waitcnt lgkmcnt(0)
  s_cmp_gt_u32 s4, 0x400000
  s_cbranch_scc1 L_poll1wx
  s_cmp_eq_u32 s82, 0
  s_cbranch_scc1 L_poll1w_l
  s_branch L_poll1wx
L_it12:
  s_branch L_itback
L_w3:
  s_waitcnt lgkmcnt(0)
  s_cmp_eq_u32 s82, 0
  s_cbranch_scc1 L_poll1w
L_poll1wx:
  buffer_load_dwordx4 v[132:135], v38, s[32:35], s87 offen sc1
  buffer_load_dwordx4 v[136:139], v38, s[32:35], s87 offen offset:256 sc1
  s_add_u32 s82, s85, 4096
  buffer_load_dwordx4 v[108:111], v35, s[32:35], s85 offen sc1
  buffer_load_dwordx4 v[112:115], v35, s[32:35], s85 offen offset:1024 sc1
  buffer_load_dwordx4 v[116:119], v35, s[32:35], s85 offen offset:2048 sc1
  buffer_load_dwordx4 v[120:123], v35, s[32:35], s85 offen offset:3072 sc1
  buffer_load_dwordx4 v[124:127], v35, s[32:35], s82 offen sc1
  buffer_load_dwordx4 v[128:131], v35, s[32:35], s82 offen offset:1024 sc1
  s_waitcnt vmcnt(8)
  ds_read_b64_tr_b16 a[48:49], v92 offset:36864
  ds_read_b64_tr_b16 a[50:51], v92 offset:38912
  ds_read_b64_tr_b16 a[52:53], v93 offset:36864
  ds_read_b64_tr_b16 a[54:55], v93 offset:38912
  ds_read_b64_tr_b16 a[56:57], v94 offset:36864
  ds_read_b64_tr_b16 a[58:59], v94 offset:38912
  ds_read_b64_tr_b16 a[60:61], v95 offset:36864
  ds_read_b64_tr_b16 a[62:63], v95 offset:38912
  ds_read_b64_tr_b16 a[64:65], v25 offset:8192
  ds_read_b64_tr_b16 a[66:67], v25 offset:10240
  ds_read_b64_tr_b16 a[68:69], v26 offset:8192
  ds_read_b64_tr_b16 a[70:71], v26 offset:10240
  ds_read_b64_tr_b16 a[72:73], v27 offset:8192
  ds_read_b64_tr_b16 a[74:75], v27 offset:10240
  ds_read_b64_tr_b16 a[76:77], v28 offset:8192
  ds_read_b64_tr_b16 a[78:79], v28 offset:10240
  ds_read_b64_tr_b16 a[80:81], v25 offset:12288
  ds_read_b64_tr_b16 a[82:83], v25 offset:14336
  ds_read_b64_tr_b16 a[84:85], v26 offset:12288
  ds_read_b64_tr_b16 a[86:87], v26 offset:14336
  ds_read_b64_tr_b16 a[88:89], v27 offset:12288
  ds_read_b64_tr_b16 a[90:91], v27 offset:14336
  ds_read_b64_tr_b16 a[92:93], v28 offset:12288
  ds_read_b64_tr_b16 a[94:95], v28 offset:14336
  ds_read_b64_tr_b16 a[96:97], v25
  ds_read_b64_tr_b16 a[98:99], v25 offset:2048
  ds_read_b64_tr_b16 a[100:101], v26
  ds_read_b64_tr_b16 a[102:103], v26 offset:2048
  ds_read_b64_tr_b16 a[104:105], v27
  ds_read_b64_tr_b16 a[106:107], v27 offset:2048
  ds_read_b64_tr_b16 a[108:109], v28
  ds_read_b64_tr_b16 a[110:111], v28 offset:2048
  ds_read_b64_tr_b16 a[112:113], v25 offset:4096
  ds_read_b64_tr_b16 a[114:115], v25 offset:6144
  ds_read_b64_tr_b16 a[116:117], v26 offset:4096
  ds_read_b64_tr_b16 a[118:119], v26 offset:6144
  ds_read_b64_tr_b16 a[120:121], v27 offset:4096
  ds_read_b64_tr_b16 a[122:123], v27 offset:6144
  ds_read_b64_tr_b16 a[124:125], v28 offset:4096
  ds_read_b64_tr_b16 a[126:127], v28 offset:6144
  s_waitcnt vmcnt(6)
  v_cmp_neq_f32 vcc, v54, v137
  v_cmp_neq_f32 s[4:5], v55, v138
  v_cmp_neq_f32 s[72:73], v56, v139
  s_waitcnt lgkmcnt(0)
  s_or_b64 vcc, vcc, s[4:5]
  s_or_b64 vcc, vcc, s[72:73]
  s_cbranch_vccnz L_rescalew
L_rescaledw:
  v_add_f32 v48, v48, v133
  v_add_f32 v49, v49, v134
  v_add_f32 v50, v50, v135
  v_rcp_f32 v48, v48
  v_rcp_f32 v49, v49
  v_rcp_f32 v50, v50
  s_waitcnt vmcnt(5)
  v_mfma_f32_16x16x32_bf16 v[156:159], v[86:89], v[108:111], v[156:159]
  v_mfma_f32_16x16x32_bf16 v[160:163], v[84:87], v[108:111], v[160:163]
  s_waitcnt vmcnt(4)
  v_mfma_f32_16x16x32_bf16 v[172:175], v[86:89], v[112:115], v[172:175]
  v_mfma_f32_16x16x32_bf16 v[176:179], v[84:87], v[112:115], v[176:179]
  s_nop 4
  v_cvt_pk_bf16_f32 v60, v156, v157
  v_cvt_pk_bf16_f32 v61, v158, v159
  v_cvt_pk_bf16_f32 v62, v160, v161
  v_cvt_pk_bf16_f32 v63, v162, v163
  ds_write_b128 v42, v[60:63]
  s_waitcnt vmcnt(3)
  v_mfma_f32_16x16x32_bf16 v[188:191], v[86:89], v[116:119], v[188:191]
  v_mfma_f32_16x16x32_bf16 v[192:195], v[84:87], v[116:119], v[192:195]
  v_cvt_pk_bf16_f32 v64, v172, v173
  v_cvt_pk_bf16_f32 v65, v174, v175
  v_cvt_pk_bf16_f32 v66, v176, v177
  v_cvt_pk_bf16_f32 v67, v178, v179
  ds_write_b128 v42, v[64:67] offset:1024
  s_waitcnt vmcnt(2)
  v_mfma_f32_16x16x32_bf16 v[164:167], v[86:89], v[120:123], v[164:167]
  v_mfma_f32_16x16x32_bf16 v[168:171], v[84:87], v[120:123], v[168:171]
  v_cvt_pk_bf16_f32 v68, v188, v189
  v_cvt_pk_bf16_f32 v69, v190, v191
  v_cvt_pk_bf16_f32 v70, v192, v193
  v_cvt_pk_bf16_f32 v71, v194, v195
  ds_write_b128 v42, v[68:71] offset:2048
  s_waitcnt vmcnt(1)
  v_mfma_f32_16x16x32_bf16 v[180:183], v[86:89], v[124:127], v[180:183]
  v_mfma_f32_16x16x32_bf16 v[184:187], v[84:87], v[124:127], v[184:187]
  v_cvt_pk_bf16_f32 v72, v164, v165
  v_cvt_pk_bf16_f32 v73, v166, v167
  v_cvt_pk_bf16_f32 v74, v168, v169
  v_cvt_pk_bf16_f32 v75, v170, v171
  ds_write_b128 v42, v[72:75] offset:3072
  s_waitcnt vmcnt(0)
  v_mfma_f32_16x16x32_bf16 v[196:199], v[86:89], v[128:131], v[196:199]
  v_mfma_f32_16x16x32_bf16 v[200:203], v[84:87], v[128:131], v[200:203]
  v_cvt_pk_bf16_f32 v76, v180, v181
  v_cvt_pk_bf16_f32 v77, v182, v183
  v_cvt_pk_bf16_f32 v78, v184, v185
  v_cvt_pk_bf16_f32 v79, v186, v187
  ds_write_b128 v42, v[76:79] offset:4096
  s_nop 1
  v_cvt_pk_bf16_f32 v80, v196, v197
  v_cvt_pk_bf16_f32 v81, v198, v199
  v_cvt_pk_bf16_f32 v82, v200, v201
  v_cvt_pk_bf16_f32 v83, v202, v203
  ds_write_b128 v42, v[80:83] offset:5120
  s_waitcnt lgkmcnt(0)
  s_barrier
  ds_read_b128 v[156:159], v34
  ds_read_b128 v[168:171], v34 offset:3072
  ds_read_b128 v[180:183], v34 offset:6144
  ds_read_b128 v[192:195], v34 offset:9216
  ds_read_b128 v[204:207], v34 offset:12288
  ds_read_b128 v[216:219], v34 offset:15360
  s_waitcnt lgkmcnt(5)
  v_mfma_f32_16x16x32_bf16 v[108:111], a[0:3], v[156:159], 0
  ds_read_b128 v[228:231], v34 offset:18432
  s_waitcnt lgkmcnt(5)
  v_mfma_f32_16x16x32_bf16 v[108:111], a[16:19], v[168:171], v[108:111]
  ds_read_b128 v[240:243], v34 offset:21504
  v_mfma_f32_16x16x32_bf16 v[112:115], a[4:7], v[156:159], 0
  ds_read_b128 v[160:163], v34 offset:1024
  v_mfma_f32_16x16x32_bf16 v[112:115], a[20:23], v[168:171], v[112:115]
  ds_read_b128 v[172:175], v34 offset:4096
  s_waitcnt lgkmcnt(7)
  v_mfma_f32_16x16x32_bf16 v[108:111], a[32:35], v[180:183], v[108:111]
  s_waitcnt lgkmcnt(6)
  v_mfma_f32_16x16x32_bf16 v[108:111], a[48:51], v[192:195], v[108:111]
  ds_read_b128 v[184:187], v34 offset:7168
  v_mfma_f32_16x16x32_bf16 v[112:115], a[36:39], v[180:183], v[112:115]
  v_mfma_f32_16x16x32_bf16 v[112:115], a[52:55], v[192:195], v[112:115]
  ds_read_b128 v[196:199], v34 offset:10240
  s_waitcnt lgkmcnt(7)
  v_mfma_f32_16x16x32_bf16 v[108:111], a[64:67], v[204:207], v[108:111]
  s_waitcnt lgkmcnt(6)
  v_mfma_f32_16x16x32_bf16 v[108:111], a[80:83], v[216:219], v[108:111]
  ds_read_b128 v[208:211], v34 offset:13312
  v_mfma_f32_16x16x32_bf16 v[112:115], a[68:71], v[204:207], v[112:115]
  v_mfma_f32_16x16x32_bf16 v[112:115], a[84:87], v[216:219], v[112:115]
  ds_read_b128 v[220:223], v34 offset:16384
  s_waitcnt lgkmcnt(7)
  v_mfma_f32_16x16x32_bf16 v[108:111], a[96:99], v[228:231], v[108:111]
  s_waitcnt lgkmcnt(6)
  v_mfma_f32_16x16x32_bf16 v[108:111], a[112:115], v[240:243], v[108:111]
  ds_read_b128 v[232:235], v34 offset:19456
  v_mfma_f32_16x16x32_bf16 v[112:115], a[100:103], v[228:231], v[112:115]
  v_mfma_f32_16x16x32_bf16 v[112:115], a[116:119], v[240:243], v[112:115]
  ds_read_b128 v[244:247], v34 offset:22528
  s_waitcnt lgkmcnt(7)
  v_mfma_f32_16x16x32_bf16 v[116:119], a[0:3], v[160:163], 0
  s_waitcnt lgkmcnt(6)
  v_mfma_f32_16x16x32_bf16 v[116:119], a[16:19], v[172:175], v[116:119]
  ds_read_b128 v[164:167], v34 offset:2048
  v_mfma_f32_16x16x32_bf16 v[120:123], a[4:7], v[160:163], 0
  v_mfma_f32_16x16x32_bf16 v[120:123], a[20:23], v[172:175], v[120:123]
  ds_read_b128 v[176:179], v34 offset:5120
  s_add_u32 s77, s91, 0
  s_waitcnt lgkmcnt(7)
  v_mfma_f32_16x16x32_bf16 v[116:119], a[32:35], v[184:187], v[116:119]
  v_mul_f32 v108, v108, v48
  v_mul_f32 v109, v109, v48
  s_waitcnt lgkmcnt(6)
  v_mfma_f32_16x16x32_bf16 v[116:119], a[48:51], v[196:199], v[116:119]
  ds_read_b128 v[188:191], v34 offset:8192
  v_mul_f32 v110, v110, v48
  v_mfma_f32_16x16x32_bf16 v[120:123], a[36:39], v[184:187], v[120:123]
  v_mul_f32 v111, v111, v48
  v_cvt_pk_bf16_f32 v60, v108, v109
  v_mfma_f32_16x16x32_bf16 v[120:123], a[52:55], v[196:199], v[120:123]
  ds_read_b128 v[200:203], v34 offset:11264
  v_cvt_pk_bf16_f32 v61, v110, v111
  s_waitcnt lgkmcnt(7)
  v_mfma_f32_16x16x32_bf16 v[116:119], a[64:67], v[208:211], v[116:119]
  v_mul_f32 v112, v112, v48
  v_mul_f32 v113, v113, v48
  s_waitcnt lgkmcnt(6)
  v_mfma_f32_16x16x32_bf16 v[116:119], a[80:83], v[220:223], v[116:119]
  ds_read_b128 v[212:215], v34 offset:14336
  v_mul_f32 v114, v114, v48
  v_mfma_f32_16x16x32_bf16 v[120:123], a[68:71], v[208:211], v[120:123]
  v_mul_f32 v115, v115, v48
  v_cvt_pk_bf16_f32 v62, v112, v113
  v_mfma_f32_16x16x32_bf16 v[120:123], a[84:87], v[220:223], v[120:123]
  ds_read_b128 v[224:227], v34 offset:17408
  v_cvt_pk_bf16_f32 v63, v114, v115
  s_waitcnt lgkmcnt(7)
  v_mfma_f32_16x16x32_bf16 v[116:119], a[96:99], v[232:235], v[116:119]
  buffer_store_dwordx4 v[60:63], v35, s[32:35], s77 offen sc1
  s_waitcnt lgkmcnt(6)
  v_mfma_f32_16x16x32_bf16 v[116:119], a[112:115], v[244:247], v[116:119]
  ds_read_b128 v[236:239], v34 offset:20480
  v_mfma_f32_16x16x32_bf16 v[120:123], a[100:103], v[232:235], v[120:123]
  v_mfma_f32_16x16x32_bf16 v[120:123], a[116:119], v[244:247], v[120:123]
  ds_read_b128 v[248:251], v34 offset:23552
  s_waitcnt lgkmcnt(7)
  v_mfma_f32_16x16x32_bf16 v[124:127], a[0:3], v[164:167], 0
  s_waitcnt lgkmcnt(6)
  v_mfma_f32_16x16x32_bf16 v[124:127], a[16:19], v[176:179], v[124:127]
  v_mfma_f32_16x16x32_bf16 v[128:131], a[4:7], v[164:167], 0
L_it13:
  s_cbranch_execz L_itback
  v_mfma_f32_16x16x32_bf16 v[128:131], a[20:23], v[176:179], v[128:131]
  s_waitcnt lgkmcnt(5)
  v_mfma_f32_16x16x32_bf16 v[124:127], a[32:35], v[188:191], v[124:127]
  v_mul_f32 v116, v116, v49
  v_mul_f32 v117, v117, v49
  s_waitcnt lgkmcnt(4)
  v_mfma_f32_16x16x32_bf16 v[124:127], a[48:51], v[200:203], v[124:127]
  v_mul_f32 v118, v118, v49
  v_mul_f32 v119, v119, v49
  v_mfma_f32_16x16x32_bf16 v[128:131], a[36:39], v[188:191], v[128:131]
  v_cvt_pk_bf16_f32 v64, v116, v117
  v_cvt_pk_bf16_f32 v65, v118, v119
  v_mfma_f32_16x16x32_bf16 v[128:131], a[52:55], v[200:203], v[128:131]
  v_mul_f32 v120, v120, v49
  v_mul_f32 v121, v121, v49
  s_waitcnt lgkmcnt(3)
  v_mfma_f32_16x16x32_bf16 v[124:127], a[64:67], v[212:215], v[124:127]
  v_mul_f32 v122, v122, v49
  v_mul_f32 v123, v123, v49
  s_waitcnt lgkmcnt(2)
  v_mfma_f32_16x16x32_bf16 v[124:127], a[80:83], v[224:227], v[124:127]
  v_cvt_pk_bf16_f32 v66, v120, v121
  v_cvt_pk_bf16_f32 v67, v122, v123
  v_mfma_f32_16x16x32_bf16 v[128:131], a[68:71], v[212:215], v[128:131]
  buffer_store_dwordx4 v[64:67], v35, s[32:35], s77 offen offset:1024 sc1
  v_mfma_f32_16x16x32_bf16 v[128:131], a[84:87], v[224:227], v[128:131]
  s_waitcnt lgkmcnt(1)
  v_mfma_f32_16x16x32_bf16 v[124:127], a[96:99], v[236:239], v[124:127]
  s_waitcnt lgkmcnt(0)
  v_mfma_f32_16x16x32_bf16 v[124:127], a[112:115], v[248:251], v[124:127]
  v_mfma_f32_16x16x32_bf16 v[128:131], a[100:103], v[236:239], v[128:131]
  v_mfma_f32_16x16x32_bf16 v[128:131], a[116:119], v[248:251], v[128:131]
  v_mfma_f32_16x16x32_bf16 v[132:135], a[8:11], v[156:159], 0
  v_mfma_f32_16x16x32_bf16 v[132:135], a[24:27], v[168:171], v[132:135]
  v_mfma_f32_16x16x32_bf16 v[136:139], a[12:15], v[156:159], 0
  v_mfma_f32_16x16x32_bf16 v[136:139], a[28:31], v[168:171], v[136:139]
  v_mfma_f32_16x16x32_bf16 v[132:135], a[40:43], v[180:183], v[132:135]
  s_nop 0
  v_mul_f32 v124, v124, v50
  v_mul_f32 v125, v125, v50
  v_mfma_f32_16x16x32_bf16 v[132:135], a[56:59], v[192:195], v[132:135]
  v_mul_f32 v126, v126, v50
  v_mul_f32 v127, v127, v50
  v_mfma_f32_16x16x32_bf16 v[136:139], a[44:47], v[180:183], v[136:139]
  v_cvt_pk_bf16_f32 v68, v124, v125
  v_cvt_pk_bf16_f32 v69, v126, v127
  v_mfma_f32_16x16x32_bf16 v[136:139], a[60:63], v[192:195], v[136:139]
  v_mul_f32 v128, v128, v50
  v_mul_f32 v129, v129, v50
  v_mfma_f32_16x16x32_bf16 v[132:135], a[72:75], v[204:207], v[132:135]
  v_mul_f32 v130, v130, v50
  v_mul_f32 v131, v131, v50
  v_mfma_f32_16x16x32_bf16 v[132:135], a[88:91], v[216:219], v[132:135]
  v_cvt_pk_bf16_f32 v70, v128, v129
  v_cvt_pk_bf16_f32 v71, v130, v131
  v_mfma_f32_16x16x32_bf16 v[136:139], a[76:79], v[204:207], v[136:139]
  buffer_store_dwordx4 v[68:71], v35, s[32:35], s77 offen offset:2048 sc1
  v_mfma_f32_16x16x32_bf16 v[136:139], a[92:95], v[216:219], v[136:139]
  v_mfma_f32_16x16x32_bf16 v[132:135], a[104:107], v[228:231], v[132:135]
  v_mfma_f32_16x16x32_bf16 v[132:135], a[120:123], v[240:243], v[132:135]
  v_mfma_f32_16x16x32_bf16 v[136:139], a[108:111], v[228:231], v[136:139]
  v_mfma_f32_16x16x32_bf16 v[136:139], a[124:127], v[240:243], v[136:139]
  v_mfma_f32_16x16x32_bf16 v[140:143], a[8:11], v[160:163], 0
  v_mfma_f32_16x16x32_bf16 v[140:143], a[24:27], v[172:175], v[140:143]
  v_mfma_f32_16x16x32_bf16 v[144:147], a[12:15], v[160:163], 0
  v_mfma_f32_16x16x32_bf16 v[144:147], a[28:31], v[172:175], v[144:147]
  s_add_u32 s78, s91, 3072
  v_mfma_f32_16x16x32_bf16 v[140:143], a[40:43], v[184:187], v[140:143]
  v_mul_f32 v132, v132, v48
  v_mul_f32 v133, v133, v48
  v_mfma_f32_16x16x32_bf16 v[140:143], a[56:59], v[196:199], v[140:143]
  v_mul_f32 v134, v134, v48
  v_mul_f32 v135, v135, v48
  v_mfma_f32_16x16x32_bf16 v[144:147], a[44:47], v[184:187], v[144:147]
  v_cvt_pk_bf16_f32 v72, v132, v133
  v_cvt_pk_bf16_f32 v73, v134, v135
  v_mfma_f32_16x16x32_bf16 v[144:147], a[60:63], v[196:199], v[144:147]
  v_mul_f32 v136, v136, v48
  v_mul_f32 v137, v137, v48
  v_mfma_f32_16x16x32_bf16 v[140:143], a[72:75], v[208:211], v[140:143]
  v_mul_f32 v138, v138, v48
  v_mul_f32 v139, v139, v48
  v_mfma_f32_16x16x32_bf16 v[140:143], a[88:91], v[220:223], v[140:143]
  v_cvt_pk_bf16_f32 v74, v136, v137
  v_cvt_pk_bf16_f32 v75, v138, v139
  v_mfma_f32_16x16x32_bf16 v[144:147], a[76:79], v[208:211], v[144:147]
  buffer_store_dwordx4 v[72:75], v35, s[32:35], s78 offen sc1
  v_mfma_f32_16x16x32_bf16 v[144:147], a[92:95], v[220:223], v[144:147]
  v_mfma_f32_16x16x32_bf16 v[140:143], a[104:107], v[232:235], v[140:143]
  v_mfma_f32_16x16x32_bf16 v[140:143], a[120:123], v[244:247], v[140:143]
  v_mfma_f32_16x16x32_bf16 v[144:147], a[108:111], v[232:235], v[144:147]
  v_mfma_f32_16x16x32_bf16 v[144:147], a[124:127], v[244:247], v[144:147]
  v_mfma_f32_16x16x32_bf16 v[148:151], a[8:11], v[164:167], 0
  v_mfma_f32_16x16x32_bf16 v[148:151], a[24:27], v[176:179], v[148:151]
  v_mfma_f32_16x16x32_bf16 v[152:155], a[12:15], v[164:167], 0
  v_mfma_f32_16x16x32_bf16 v[152:155], a[28:31], v[176:179], v[152:155]
  v_mfma_f32_16x16x32_bf16 v[148:151], a[40:43], v[188:191], v[148:151]
  s_nop 0
  v_mul_f32 v140, v140, v49
  v_mul_f32 v141, v141, v49
  v_mfma_f32_16x16x32_bf16 v[148:151], a[56:59], v[200:203], v[148:151]
  v_mul_f32 v142, v142, v49
  v_mul_f32 v143, v143, v49
  v_mfma_f32_16x16x32_bf16 v[152:155], a[44:47], v[188:191], v[152:155]
  v_cvt_pk_bf16_f32 v76, v140, v141
  v_cvt_pk_bf16_f32 v77, v142, v143
  v_mfma_f32_16x16x32_bf16 v[152:155], a[60:63], v[200:203], v[152:155]
  v_mul_f32 v144, v144, v49
  v_mul_f32 v145, v145, v49
  v_mfma_f32_16x16x32_bf16 v[148:151], a[72:75], v[212:215], v[148:151]
  v_mul_f32 v146, v146, v49
  v_mul_f32 v147, v147, v49
  v_mfma_f32_16x16x32_bf16 v[148:151], a[88:91], v[224:227], v[148:151]
  v_cvt_pk_bf16_f32 v78, v144, v145
  v_cvt_pk_bf16_f32 v79, v146, v147
  v_mfma_f32_16x16x32_bf16 v[152:155], a[76:79], v[212:215], v[152:155]
  buffer_store_dwordx4 v[76:79], v35, s[32:35], s78 offen offset:1024 sc1
  v_mfma_f32_16x16x32_bf16 v[152:155], a[92:95], v[224:227], v[152:155]
  v_mfma_f32_16x16x32_bf16 v[148:151], a[104:107], v[236:239], v[148:151]
  v_mfma_f32_16x16x32_bf16 v[148:151], a[120:123], v[248:251], v[148:151]
  v_mfma_f32_16x16x32_bf16 v[152:155], a[108:111], v[236:239], v[152:155]
  v_mfma_f32_16x16x32_bf16 v[152:155], a[124:127], v[248:251], v[152:155]
  s_nop 5
  v_mul_f32 v148, v148, v50
  v_mul_f32 v149, v149, v50
  v_mul_f32 v150, v150, v50
  v_mul_f32 v151, v151, v50
  v_cvt_pk_bf16_f32 v80, v148, v149
  v_cvt_pk_bf16_f32 v81, v150, v151
  v_mul_f32 v152, v152, v50
  v_mul_f32 v153, v153, v50
  v_mul_f32 v154, v154, v50
  v_mul_f32 v155, v155, v50
  v_cvt_pk_bf16_f32 v82, v152, v153
  v_cvt_pk_bf16_f32 v83, v154, v155
  buffer_store_dwordx4 v[80:83], v35, s[32:35], s78 offen offset:2048 sc1
  s_branch L_opdone
L_gowait:
  s_mov_b32 s4, 0
  s_lshl_b32 s95, s58, 2
L_gowait_l:
  s_load_dword s82, s[52:53], s95 glc
  s_add_u32 s4, s4, 1
  s_waitcnt lgkmcnt(0)
  s_cmp_gt_u32 s4, 0x400000
  s_cbranch_scc1 L_go
  s_cmp_eq_u32 s82, 0
  s_cbranch_scc1 L_gowait_l
  s_branch L_go
L_rescalew:
L_rescale:
  s_waitcnt vmcnt(0)
  v_min_f32 v43, v54, v137
  v_sub_f32 v60, v43, v54
  v_sub_f32 v64, v43, v137
  v_exp_f32 v60, v60
  v_exp_f32 v64, v64
  v_min_f32 v43, v55, v138
  v_sub_f32 v61, v43, v55
  v_sub_f32 v65, v43, v138
  v_exp_f32 v61, v61
  v_exp_f32 v65, v65
  v_min_f32 v43, v56, v139
  v_sub_f32 v62, v43, v56
  v_sub_f32 v66, v43, v139
  v_exp_f32 v62, v62
  v_exp_f32 v66, v66
  v_mul_f32 v48, v48, v60
  v_mul_f32 v133, v133, v64
  v_mul_f32 v49, v49, v61
  v_mul_f32 v134, v134, v65
  v_mul_f32 v50, v50, v62
  v_mul_f32 v135, v135, v66
  v_lshlrev_b32 v43, 16, v108
  v_and_b32 v44, 0xffff0000, v108
  v_mul_f32 v43, v43, v64
  v_mul_f32 v44, v44, v64
  v_fma_f32 v156, v156, v60, v43
  v_fma_f32 v157, v157, v60, v44
  v_mov_b32 v108, 0
  v_lshlrev_b32 v43, 16, v109
  v_and_b32 v44, 0xffff0000, v109
  v_mul_f32 v43, v43, v64
  v_mul_f32 v44, v44, v64
  v_fma_f32 v158, v158, v60, v43
  v_fma_f32 v159, v159, v60, v44
  v_mov_b32 v109, 0
  v_lshlrev_b32 v43, 16, v110
  v_and_b32 v44, 0xffff0000, v110
  v_mul_f32 v43, v43, v64
  v_mul_f32 v44, v44, v64
  v_fma_f32 v160, v160, v60, v43
  v_fma_f32 v161, v161, v60, v44
  v_mov_b32 v110, 0
  v_lshlrev_b32 v43, 16, v111
  v_and_b32 v44, 0xffff0000, v111
  v_mul_f32 v43, v43, v64
  v_mul_f32 v44, v44, v64
  v_fma_f32 v162, v162, v60, v43
  v_fma_f32 v163, v163, v60, v44
  v_mov_b32 v111, 0
  v_lshlrev_b32 v43, 16, v112
  v_and_b32 v44, 0xffff0000, v112
  v_mul_f32 v43, v43, v65
  v_mul_f32 v44, v44, v65
  v_fma_f32 v172, v172, v61, v43
  v_fma_f32 v173, v173, v61, v44
  v_mov_b32 v112, 0
  v_lshlrev_b32 v43, 16, v113
  v_and_b32 v44, 0xffff0000, v113
  v_mul_f32 v43, v43, v65
  v_mul_f32 v44, v44, v65
  v_fma_f32 v174, v174, v61, v43
  v_fma_f32 v175, v175, v61, v44
  v_mov_b32 v113, 0
  v_lshlrev_b32 v43, 16, v114
  v_and_b32 v44, 0xffff0000, v114
  v_mul_f32 v43, v43, v65
  v_mul_f32 v44, v44, v65
  v_fma_f32 v176, v176, v61, v43
  v_fma_f32 v177, v177, v61, v44
  v_mov_b32 v114, 0
  v_lshlrev_b32 v43, 16, v115
  v_and_b32 v44, 0xffff0000, v115
  v_mul_f32 v43, v43, v65
  v_mul_f32 v44, v44, v65
  v_fma_f32 v178, v178, v61, v43
  v_fma_f32 v179, v179, v61, v44
  v_mov_b32 v115, 0
  v_lshlrev_b32 v43, 16, v116
  v_and_b32 v44, 0xffff0000, v116
  v_mul_f32 v43, v43, v66
  v_mul_f32 v44, v44, v66
  v_fma_f32 v188, v188, v62, v43
  v_fma_f32 v189, v189, v62, v44
  v_mov_b32 v116, 0
  v_lshlrev_b32 v43, 16, v117
  v_and_b32 v44, 0xffff0000, v117
  v_mul_f32 v43, v43, v66
  v_mul_f32 v44, v44, v66
  v_fma_f32 v190, v190, v62, v43
  v_fma_f32 v191, v191, v62, v44
  v_mov_b32 v117, 0
  v_lshlrev_b32 v43, 16, v118
  v_and_b32 v44, 0xffff0000, v118
  v_mul_f32 v43, v43, v66
  v_mul_f32 v44, v44, v66
  v_fma_f32 v192, v192, v62, v43
  v_fma_f32 v193, v193, v62, v44
  v_mov_b32 v118, 0
  v_lshlrev_b32 v43, 16, v119
  v_and_b32 v44, 0xffff0000, v119
  v_mul_f32 v43, v43, v66
  v_mul_f32 v44, v44, v66
  v_fma_f32 v194, v194, v62, v43
  v_fma_f32 v195, v195, v62, v44
  v_mov_b32 v119, 0
  v_lshlrev_b32 v43, 16, v120
  v_and_b32 v44, 0xffff0000, v120
  v_mul_f32 v43, v43, v64
  v_mul_f32 v44, v44, v64
  v_fma_f32 v164, v164, v60, v43
  v_fma_f32 v165, v165, v60, v44
  v_mov_b32 v120, 0
  v_lshlrev_b32 v43, 16, v121
  v_and_b32 v44, 0xffff0000, v121
  v_mul_f32 v43, v43, v64
  v_mul_f32 v44, v44, v64
  v_fma_f32 v166, v166, v60, v43
  v_fma_f32 v167, v167, v60, v44
  v_mov_b32 v121, 0
  v_lshlrev_b32 v43, 16, v122
  v_and_b32 v44, 0xffff0000, v122
  v_mul_f32 v43, v43, v64
  v_mul_f32 v44, v44, v64
  v_fma_f32 v168, v168, v60, v43
  v_fma_f32 v169, v169, v60, v44
  v_mov_b32 v122, 0
  v_lshlrev_b32 v43, 16, v123
  v_and_b32 v44, 0xffff0000, v123
  v_mul_f32 v43, v43, v64
  v_mul_f32 v44, v44, v64
  v_fma_f32 v170, v170, v60, v43
  v_fma_f32 v171, v171, v60, v44
  v_mov_b32 v123, 0
  v_lshlrev_b32 v43, 16, v124
  v_and_b32 v44, 0xffff0000, v124
  v_mul_f32 v43, v43, v65
  v_mul_f32 v44, v44, v65
  v_fma_f32 v180, v180, v61, v43
  v_fma_f32 v181, v181, v61, v44
  v_mov_b32 v124, 0
  v_lshlrev_b32 v43, 16, v125
  v_and_b32 v44, 0xffff0000, v125
  v_mul_f32 v43, v43, v65
  v_mul_f32 v44, v44, v65
  v_fma_f32 v182, v182, v61, v43
  v_fma_f32 v183, v183, v61, v44
  v_mov_b32 v125, 0
  v_lshlrev_b32 v43, 16, v126
  v_and_b32 v44, 0xffff0000, v126
  v_mul_f32 v43, v43, v65
  v_mul_f32 v44, v44, v65
  v_fma_f32 v184, v184, v61, v43
  v_fma_f32 v185, v185, v61, v44
  v_mov_b32 v126, 0
  v_lshlrev_b32 v43, 16, v127
  v_and_b32 v44, 0xffff0000, v127
  v_mul_f32 v43, v43, v65
  v_mul_f32 v44, v44, v65
  v_fma_f32 v186, v186, v61, v43
  v_fma_f32 v187, v187, v61, v44
  v_mov_b32 v127, 0
  v_lshlrev_b32 v43, 16, v128
  v_and_b32 v44, 0xffff0000, v128
  v_mul_f32 v43, v43, v66
  v_mul_f32 v44, v44, v66
  v_fma_f32 v196, v196, v62, v43
  v_fma_f32 v197, v197, v62, v44
  v_mov_b32 v128, 0
  v_lshlrev_b32 v43, 16, v129
  v_and_b32 v44, 0xffff0000, v129
  v_mul_f32 v43, v43, v66
  v_mul_f32 v44, v44, v66
  v_fma_f32 v198, v198, v62, v43
  v_fma_f32 v199, v199, v62, v44
  v_mov_b32 v129, 0
  v_lshlrev_b32 v43, 16, v130
  v_and_b32 v44, 0xffff0000, v130
  v_mul_f32 v43, v43, v66
  v_mul_f32 v44, v44, v66
  v_fma_f32 v200, v200, v62, v43
  v_fma_f32 v201, v201, v62, v44
  v_mov_b32 v130, 0
  v_lshlrev_b32 v43, 16, v131
  v_and_b32 v44, 0xffff0000, v131
  v_mul_f32 v43, v43, v66
  v_mul_f32 v44, v44, v66
  v_fma_f32 v202, v202, v62, v43
  v_fma_f32 v203, v203, v62, v44
  v_mov_b32 v131, 0
  s_nop 1
  s_cmp_eq_u32 s56, 3
  s_cbranch_scc1 L_rescaledw
  s_branch L_rescaled

L_fallback:
  s_cmp_lg_u32 s93, 0
  s_cbranch_scc1 L_checked
  s_mov_b32 s93, 1
  s_waitcnt vmcnt(0) lgkmcnt(0)
  s_nop 15
  s_barrier
  v_and_b32 v43, 15, v1
  v_lshlrev_b32 v43, 9, v43
  v_lshrrev_b32 v44, 4, v1
  v_lshl_add_u32 v43, v44, 4, v43
  s_and_b32 s82, s62, 0xfffc0000
  s_mov_b32 s95, 0
  v_mov_b32 v54, 0xff800000
  v_mov_b32 v55, 0xff800000
  v_mov_b32 v56, 0xff800000
  v_mov_b32 v57, 0xff800000
  v_mov_b32 v58, 0xff800000
  v_mov_b32 v59, 0xff800000
L_fb1:
  buffer_load_dwordx4 a[192:195], v43, s[12:15], s82 offen
  buffer_load_dwordx4 a[196:199], v43, s[12:15], s82 offen offset:64
  buffer_load_dwordx4 a[200:203], v43, s[12:15], s82 offen offset:128
  buffer_load_dwordx4 a[204:207], v43, s[12:15], s82 offen offset:192
  buffer_load_dwordx4 a[208:211], v43, s[12:15], s82 offen offset:256
  buffer_load_dwordx4 a[212:215], v43, s[12:15], s82 offen offset:320
  buffer_load_dwordx4 a[216:219], v43, s[12:15], s82 offen offset:384
  buffer_load_dwordx4 a[220:223], v43, s[12:15], s82 offen offset:448
  s_waitcnt vmcnt(7)
  v_mfma_f32_16x16x32_bf16 v[60:63], a[192:195], a[0:3], 0
  s_waitcnt vmcnt(6)
  v_mfma_f32_16x16x32_bf16 v[60:63], a[196:199], a[24:27], v[60:63]
  s_waitcnt vmcnt(5)
  v_mfma_f32_16x16x32_bf16 v[60:63], a[200:203], a[48:51], v[60:63]
  s_waitcnt vmcnt(4)
  v_mfma_f32_16x16x32_bf16 v[60:63], a[204:207], a[72:75], v[60:63]
  s_waitcnt vmcnt(3)
  v_mfma_f32_16x16x32_bf16 v[60:63], a[208:211], a[96:99], v[60:63]
  s_waitcnt vmcnt(2)
  v_mfma_f32_16x16x32_bf16 v[60:63], a[212:215], a[120:123], v[60:63]
  s_waitcnt vmcnt(1)
  v_mfma_f32_16x16x32_bf16 v[60:63], a[216:219], a[144:147], v[60:63]
  s_waitcnt vmcnt(0)
  v_mfma_f32_16x16x32_bf16 v[60:63], a[220:223], a[168:171], v[60:63]
  v_mfma_f32_16x16x32_bf16 v[64:67], a[192:195], a[4:7], 0
  v_mfma_f32_16x16x32_bf16 v[64:67], a[196:199], a[28:31], v[64:67]
  v_mfma_f32_16x16x32_bf16 v[64:67], a[200:203], a[52:55], v[64:67]
  v_mfma_f32_16x16x32_bf16 v[64:67], a[204:207], a[76:79], v[64:67]
  v_mfma_f32_16x16x32_bf16 v[64:67], a[208:211], a[100:103], v[64:67]
  v_mfma_f32_16x16x32_bf16 v[64:67], a[212:215], a[124:127], v[64:67]
  v_mfma_f32_16x16x32_bf16 v[64:67], a[216:219], a[148:151], v[64:67]
  v_mfma_f32_16x16x32_bf16 v[64:67], a[220:223], a[172:175], v[64:67]
  v_mfma_f32_16x16x32_bf16 v[68:71], a[192:195], a[8:11], 0
  v_mfma_f32_16x16x32_bf16 v[68:71], a[196:199], a[32:35], v[68:71]
  v_mfma_f32_16x16x32_bf16 v[68:71], a[200:203], a[56:59], v[68:71]
  v_mfma_f32_16x16x32_bf16 v[68:71], a[204:207], a[80:83], v[68:71]
  v_mfma_f32_16x16x32_bf16 v[68:71], a[208:211], a[104:107], v[68:71]
  v_mfma_f32_16x16x32_bf16 v[68:71], a[212:215], a[128:131], v[68:71]
  v_mfma_f32_16x16x32_bf16 v[68:71], a[216:219], a[152:155], v[68:71]
  v_mfma_f32_16x16x32_bf16 v[68:71], a[220:223], a[176:179], v[68:71]
  v_mfma_f32_16x16x32_bf16 v[72:75], a[192:195], a[12:15], 0
  v_mfma_f32_16x16x32_bf16 v[72:75], a[196:199], a[36:39], v[72:75]
  v_mfma_f32_16x16x32_bf16 v[72:75], a[200:203], a[60:63], v[72:75]
  v_mfma_f32_16x16x32_bf16 v[72:75], a[204:207], a[84:87], v[72:75]
  v_mfma_f32_16x16x32_bf16 v[72:75], a[208:211], a[108:111], v[72:75]
  v_mfma_f32_16x16x32_bf16 v[72:75], a[212:215], a[132:135], v[72:75]
  v_mfma_f32_16x16x32_bf16 v[72:75], a[216:219], a[156:159], v[72:75]
  v_mfma_f32_16x16x32_bf16 v[72:75], a[220:223], a[180:183], v[72:75]
  v_mfma_f32_16x16x32_bf16 v[76:79], a[192:195], a[16:19], 0
  v_mfma_f32_16x16x32_bf16 v[76:79], a[196:199], a[40:43], v[76:79]
  v_mfma_f32_16x16x32_bf16 v[76:79], a[200:203], a[64:67], v[76:79]
  v_mfma_f32_16x16x32_bf16 v[76:79], a[204:207], a[88:91], v[76:79]
  v_mfma_f32_16x16x32_bf16 v[76:79], a[208:211], a[112:115], v[76:79]
  v_mfma_f32_16x16x32_bf16 v[76:79], a[212:215], a[136:139], v[76:79]
  v_mfma_f32_16x16x32_bf16 v[76:79], a[216:219], a[160:163], v[76:79]
  v_mfma_f32_16x16x32_bf16 v[76:79], a[220:223], a[184:187], v[76:79]
  v_mfma_f32_16x16x32_bf16 v[80:83], a[192:195], a[20:23], 0
  v_mfma_f32_16x16x32_bf16 v[80:83], a[196:199], a[44:47], v[80:83]
  v_mfma_f32_16x16x32_bf16 v[80:83], a[200:203], a[68:71], v[80:83]
  v_mfma_f32_16x16x32_bf16 v[80:83], a[204:207], a[92:95], v[80:83]
  v_mfma_f32_16x16x32_bf16 v[80:83], a[208:211], a[116:119], v[80:83]
  v_mfma_f32_16x16x32_bf16 v[80:83], a[212:215], a[140:143], v[80:83]
  v_mfma_f32_16x16x32_bf16 v[80:83], a[216:219], a[164:167], v[80:83]
  v_mfma_f32_16x16x32_bf16 v[80:83], a[220:223], a[188:191], v[80:83]
  v_max3_f32 v54, v54, v60, v61
  v_max3_f32 v54, v54, v62, v63
  v_max3_f32 v55, v55, v64, v65
  v_max3_f32 v55, v55, v66, v67
  v_max3_f32 v56, v56, v68, v69
  v_max3_f32 v56, v56, v70, v71
  v_max3_f32 v57, v57, v72, v73
  v_max3_f32 v57, v57, v74, v75
  v_max3_f32 v58, v58, v76, v77
  v_max3_f32 v58, v58, v78, v79
  v_max3_f32 v59, v59, v80, v81
  v_max3_f32 v59, v59, v82, v83
  s_add_u32 s82, s82, 8192
  s_add_u32 s95, s95, 1
  s_cmp_lt_u32 s95, 32
  s_cbranch_scc1 L_fb1
  v_mov_b32 v44, v54
  s_nop 1
  v_permlane32_swap_b32 v44, v54
  v_max_f32 v54, v54, v44
  v_mov_b32 v44, v54
  s_nop 1
  v_permlane16_swap_b32 v44, v54
  v_max_f32 v54, v54, v44
  v_mul_f32 v54, s94, v54
  v_sub_f32 v54, 0, v54
  v_mov_b32 v44, v55
  s_nop 1
  v_permlane32_swap_b32 v44, v55
  v_max_f32 v55, v55, v44
  v_mov_b32 v44, v55
  s_nop 1
  v_permlane16_swap_b32 v44, v55
  v_max_f32 v55, v55, v44
  v_mul_f32 v55, s94, v55
  v_sub_f32 v55, 0, v55
  v_mov_b32 v44, v56
  s_nop 1
  v_permlane32_swap_b32 v44, v56
  v_max_f32 v56, v56, v44
  v_mov_b32 v44, v56
  s_nop 1
  v_permlane16_swap_b32 v44, v56
  v_max_f32 v56, v56, v44
  v_mul_f32 v56, s94, v56
  v_sub_f32 v56, 0, v56
  v_mov_b32 v44, v57
  s_nop 1
  v_permlane32_swap_b32 v44, v57
  v_max_f32 v57, v57, v44
  v_mov_b32 v44, v57
  s_nop 1
  v_permlane16_swap_b32 v44, v57
  v_max_f32 v57, v57, v44
  v_mul_f32 v57, s94, v57
  v_sub_f32 v57, 0, v57
  v_mov_b32 v44, v58
  s_nop 1
  v_permlane32_swap_b32 v44, v58
  v_max_f32 v58, v58, v44
  v_mov_b32 v44, v58
  s_nop 1
  v_permlane16_swap_b32 v44, v58
  v_max_f32 v58, v58, v44
  v_mul_f32 v58, s94, v58
  v_sub_f32 v58, 0, v58
  v_mov_b32 v44, v59
  s_nop 1
  v_permlane32_swap_b32 v44, v59
  v_max_f32 v59, v59, v44
  v_mov_b32 v44, v59
  s_nop 1
  v_permlane16_swap_b32 v44, v59
  v_max_f32 v59, v59, v44
  v_mul_f32 v59, s94, v59
  v_sub_f32 v59, 0, v59
  ds_write_b128 v32, a[0:3]
  ds_write_b128 v32, a[4:7] offset:2048
  ds_write_b128 v32, a[8:11] offset:4096
  ds_write_b128 v32, a[12:15] offset:6144
  ds_write_b128 v34, a[16:19] offset:16384
  ds_write_b128 v34, a[20:23] offset:18432
  ds_write_b128 v32, a[24:27] offset:1024
  ds_write_b128 v32, a[28:31] offset:3072
  ds_write_b128 v32, a[32:35] offset:5120
  ds_write_b128 v32, a[36:39] offset:7168
  ds_write_b128 v34, a[40:43] offset:17408
  ds_write_b128 v34, a[44:47] offset:19456
  ds_write_b128 v32, a[48:51] offset:16384
  ds_write_b128 v32, a[52:55] offset:18432
  ds_write_b128 v32, a[56:59] offset:20480
  ds_write_b128 v32, a[60:63] offset:22528
  ds_write_b128 v34, a[64:67] offset:20480
  ds_write_b128 v34, a[68:71] offset:22528
  ds_write_b128 v32, a[72:75] offset:17408
  ds_write_b128 v32, a[76:79] offset:19456
  ds_write_b128 v32, a[80:83] offset:21504
  ds_write_b128 v32, a[84:87] offset:23552
  ds_write_b128 v34, a[88:91] offset:21504
  ds_write_b128 v34, a[92:95] offset:23552
  ds_write_b128 v32, a[96:99] offset:32768
  ds_write_b128 v32, a[100:103] offset:34816
  ds_write_b128 v32, a[104:107] offset:36864
  ds_write_b128 v32, a[108:111] offset:38912
  ds_write_b128 v34, a[112:115] offset:24576
  ds_write_b128 v34, a[116:119] offset:26624
  ds_write_b128 v32, a[120:123] offset:33792
  ds_write_b128 v32, a[124:127] offset:35840
  ds_write_b128 v32, a[128:131] offset:37888
  ds_write_b128 v32, a[132:135] offset:39936
  ds_write_b128 v34, a[136:139] offset:25600
  ds_write_b128 v34, a[140:143] offset:27648
  ds_write_b128 v32, a[144:147] offset:49152
  ds_write_b128 v32, a[148:151] offset:51200
  ds_write_b128 v32, a[152:155] offset:53248
  ds_write_b128 v32, a[156:159] offset:55296
  ds_write_b128 v34, a[160:163] offset:28672
  ds_write_b128 v34, a[164:167] offset:30720
  ds_write_b128 v32, a[168:171] offset:50176
  ds_write_b128 v32, a[172:175] offset:52224
  ds_write_b128 v32, a[176:179] offset:54272
  ds_write_b128 v32, a[180:183] offset:56320
  ds_write_b128 v34, a[184:187] offset:29696
  ds_write_b128 v34, a[188:191] offset:31744
  s_add_u32 m0, s64, 0
  s_xor_b32 s6, s62, 0
  buffer_load_dwordx4 v2, s[12:15], s6 offen nt lds
  buffer_load_dwordx4 v3, s[12:15], s6 offen offset:1024 nt lds
  buffer_load_dwordx4 v4, s[12:15], s6 offen offset:2048 nt lds
  buffer_load_dwordx4 v5, s[12:15], s6 offen offset:3072 nt lds
  s_add_u32 m0, s64, 4096
  s_nop 0
  buffer_load_dwordx4 v6, s[12:15], s6 offen nt lds
  buffer_load_dwordx4 v7, s[12:15], s6 offen offset:1024 nt lds
  buffer_load_dwordx4 v8, s[12:15], s6 offen offset:2048 nt lds
  buffer_load_dwordx4 v9, s[12:15], s6 offen offset:3072 nt lds
  s_add_u32 m0, s64, 32768
  s_xor_b32 s6, s62, 8192
  buffer_load_dwordx4 v2, s[12:15], s6 offen nt lds
  buffer_load_dwordx4 v3, s[12:15], s6 offen offset:1024 nt lds
  buffer_load_dwordx4 v4, s[12:15], s6 offen offset:2048 nt lds
  buffer_load_dwordx4 v5, s[12:15], s6 offen offset:3072 nt lds
  s_add_u32 m0, s64, 36864
  s_nop 0
  buffer_load_dwordx4 v6, s[12:15], s6 offen nt lds
  buffer_load_dwordx4 v7, s[12:15], s6 offen offset:1024 nt lds
  buffer_load_dwordx4 v8, s[12:15], s6 offen offset:2048 nt lds
  buffer_load_dwordx4 v9, s[12:15], s6 offen offset:3072 nt lds
  s_add_u32 m0, s65, 8192
  s_xor_b32 s6, s63, 0
  buffer_load_dwordx4 v10, s[16:19], s6 offen nt lds
  buffer_load_dwordx4 v11, s[16:19], s6 offen offset:1024 nt lds
  buffer_load_dwordx4 v12, s[16:19], s6 offen offset:2048 nt lds
  buffer_load_dwordx4 v13, s[16:19], s6 offen offset:3072 nt lds
  s_add_u32 m0, s65, 12288
  s_xor_b32 s6, s63, 32768
  buffer_load_dwordx4 v10, s[16:19], s6 offen nt lds
  buffer_load_dwordx4 v11, s[16:19], s6 offen offset:1024 nt lds
  buffer_load_dwordx4 v12, s[16:19], s6 offen offset:2048 nt lds
  buffer_load_dwordx4 v13, s[16:19], s6 offen offset:3072 nt lds
  s_add_u32 m0, s65, 12288
  s_xor_b32 s6, s63, 32768
  s_waitcnt vmcnt(0) lgkmcnt(0)
  s_nop 7
  s_branch L_attn
  s_endpgm
.if (. - standalone__gqa_block_cached__near_ridge_kernel) < 33024
.error "code shorter than the prefetched range"
.endif
.section .rodata,"a"
.p2align 6
.amdhsa_kernel standalone__gqa_block_cached__near_ridge_kernel
  .amdhsa_next_free_vgpr 512
  .amdhsa_next_free_sgpr 102
  .amdhsa_accum_offset 256
  .amdhsa_group_segment_fixed_size 0
  .amdhsa_kernarg_size 64
  .amdhsa_user_sgpr_count 2
  .amdhsa_user_sgpr_kernarg_segment_ptr 1
  .amdhsa_system_sgpr_workgroup_id_x 1
.end_amdhsa_kernel
```
